```python
import torch

def _softmax(x, axis=-1):
    return torch.softmax(x, dim=axis)
def _gelu(x):
    return torch.nn.functional.gelu(x, approximate="tanh")
def _silu(x):
    return torch.nn.functional.silu(x)
def _sigmoid(x):
    return torch.sigmoid(x)
def _layernorm(x, axis=-1, eps=1e-5):
    m = x.mean(dim=axis, keepdim=True)
    v = x.var(dim=axis, keepdim=True, unbiased=False)
    return (x - m) / torch.sqrt(v + eps)
def _scatter_add(tgt, idx, src, axis=0):
    return tgt.clone().index_add_(axis, idx, src)
def _segment_sum(src, seg, n):
    out = torch.zeros((n,) + src.shape[1:], dtype=src.dtype)
    return out.index_add_(0, seg, src)
def _pad(x, pw):
    flat = tuple(v for pair in reversed(pw) for v in pair)
    return torch.nn.functional.pad(x, flat)

kernel_name = 'standalone__dense_activation_gelu__prompt'

def setup_inputs():

    _w = (lambda a: (lambda t: t.to(torch.bfloat16) if t.is_floating_point() else t)(torch.as_tensor(a)))
    B, S, D, F = 1, 2048, 448, 1792
    return {
        "x": _w((lambda *s: torch.randn(*s, dtype=torch.bfloat16) * 0.05)(B, S, D)),
        "w1": _w((lambda *s: torch.randn(*s, dtype=torch.bfloat16) * 3.2)(D, F) * (D ** -0.5)),
        "b1": _w((lambda *s: torch.randn(*s, dtype=torch.bfloat16) * 3.2)(F) * 0.01),
        "w2": _w((lambda *s: torch.randn(*s, dtype=torch.bfloat16) * 0.05)(F, D) * (F ** -0.5)),
        "b2": _w((lambda *s: torch.randn(*s, dtype=torch.bfloat16) * 0.1)(D) * 0.01),
    }

def reference(x, w1, b1, w2, b2):
    h = torch.einsum("bsd,df->bsf", x, w1) + b1
    h = _gelu(h)
    return torch.einsum("bsf,fd->bsd", h, w2) + b2
```

```asm
; @launch grid=(256,1,1) block=(256,1,1) lds=163840
.amdgcn_target "amdgcn-amd-amdhsa--gfx950"
.text
.globl standalone__dense_activation_gelu__prompt_kernel
.p2align 8
.type standalone__dense_activation_gelu__prompt_kernel,@function
standalone__dense_activation_gelu__prompt_kernel:
  s_cmp_ge_u32 s2, 224
  s_cbranch_scc1 L_spare
  s_load_dwordx16 s[4:19], s[0:1], 0
  v_and_b32 v1, 63, v0
  v_lshrrev_b32 v38, 6, v0
  s_and_b32 s53, s2, 7
  v_readfirstlane_b32 s52, v38
  s_nop 3
  s_cmp_lg_u32 s52, 1
  s_cbranch_scc1 L_nocpf
  s_getpc_b64 s[60:61]
L_pc:
  s_lshr_b32 s62, s2, 3
  s_mul_i32 s62, s62, 4
  v_min_u32 v42, 3, v1
  v_add_lshl_u32 v42, v42, s62, 7
  v_min_u32 v42, L_end-L_pc, v42
  global_load_dword v37, v42, s[60:61]
L_nocpf:
  s_lshr_b32 s60, s2, 3
  s_mul_i32 s54, s60, 37
  s_lshr_b32 s54, s54, 8
  s_mul_i32 s61, s54, 7
  s_sub_u32 s55, s60, s61
  s_lshr_b32 s56, s53, 1
  s_lshl_b32 s56, s56, 2
  s_add_u32 s56, s56, s54
  s_and_b32 s57, s53, 1
  s_mul_i32 s57, s57, 7
  s_add_u32 s57, s57, s55
  s_lshl_b32 s59, s53, 2
  s_add_u32 s59, s59, s54
  s_lshl_b32 s58, s54, 1
  s_add_u32 s58, s58, s55
  s_add_u32 s58, s58, s53
  s_mul_i32 s60, s58, 37
  s_lshr_b32 s60, s60, 8
  s_mul_i32 s60, s60, 7
  s_sub_u32 s58, s58, s60
  v_lshrrev_b32 v38, 3, v1
  v_and_b32 v39, 7, v1
  v_lshrrev_b32 v40, 1, v38
  v_xor_b32 v41, v39, v40
  v_xor_b32 v42, 4, v41
  v_mul_u32_u24 v43, 896, v38
  v_lshl_add_u32 v2, v41, 4, v43
  v_lshl_add_u32 v3, v42, 4, v43
  v_add_u32 v3, 7168, v3
  v_and_b32 v40, 1, v40
  v_lshlrev_b32 v40, 2, v40
  v_xor_b32 v40, v39, v40
  v_lshl_add_u32 v5, v40, 4, v43
  v_add_u32 v60, 6144, v5
  v_add_u32 v61, 12288, v5
  v_add_u32 v62, 18432, v5
  v_mul_u32_u24 v43, 3584, v38
  v_lshl_add_u32 v4, v40, 4, v43
  s_lshl_b32 s60, s56, 2
  s_add_u32 s60, s60, s52
  s_mul_i32 s64, s60, 28672
  s_mul_i32 s65, s52, 57344
  s_lshl_b32 s60, s57, 8
  s_add_u32 s65, s65, s60
  s_lshl_b32 s66, s52, 12
  s_lshl_b32 s67, s52, 11
  s_mov_b32 s68, s58
  s_mov_b32 s22, 1835008
  s_mov_b32 s23, 0x20000
  s_mov_b32 s26, 1605632
  s_mov_b32 s27, 0x20000
  s_mov_b32 s30, 1605632
  s_mov_b32 s31, 0x20000
  s_mov_b32 s34, 268435456
  s_mov_b32 s35, 0x20000
  s_mov_b32 s38, 1835008
  s_mov_b32 s39, 0x20000
  s_mov_b32 s42, 3584
  s_mov_b32 s43, 0x20000
  s_mov_b32 s46, 896
  s_mov_b32 s47, 0x20000
  s_mov_b32 s50, 256
  s_mov_b32 s51, 0x20000
  v_and_b32 v38, 31, v1
  v_lshrrev_b32 v39, 5, v1
  v_bfe_u32 v40, v1, 1, 3
  v_xor_b32 v40, v40, v39
  v_lshlrev_b32 v38, 7, v38
  v_add_u32 v38, s66, v38
  v_xor_b32 v41, 0, v40
  v_lshl_add_u32 v6, v41, 4, v38
  v_add_u32 v10, 49152, v6
  v_xor_b32 v41, 2, v40
  v_lshl_add_u32 v7, v41, 4, v38
  v_add_u32 v11, 49152, v7
  v_xor_b32 v41, 4, v40
  v_lshl_add_u32 v8, v41, 4, v38
  v_add_u32 v12, 49152, v8
  v_xor_b32 v41, 6, v40
  v_lshl_add_u32 v9, v41, 4, v38
  v_add_u32 v13, 49152, v9
  v_bfe_u32 v38, v1, 2, 2
  v_and_b32 v40, 3, v1
  v_bfe_u32 v41, v1, 4, 1
  v_lshlrev_b32 v40, 3, v40
  v_lshl_add_u32 v40, v41, 5, v40
  v_lshl_add_u32 v41, v39, 3, v38
  v_lshl_add_u32 v41, v41, 7, v40
  v_lshrrev_b32 v42, 1, v38
  v_lshl_add_u32 v43, v42, 6, v41
  v_add_u32 v14, 16384, v43
  v_add_u32 v16, 65536, v43
  v_add_u32 v18, 98304, v43
  v_xor_b32 v43, 64, v43
  v_add_u32 v15, 16384, v43
  v_add_u32 v17, 65536, v43
  v_add_u32 v19, 98304, v43
  s_lshl_b32 s71, s52, 13
  v_lshl_add_u32 v41, v39, 2, v38
  v_lshl_add_u32 v41, v41, 7, v40
  v_add_u32 v41, s71, v41
  s_lshr_b32 s60, s52, 1
  v_xor_b32 v42, s60, v42
  v_lshl_add_u32 v20, v42, 6, v41
  v_xor_b32 v21, 64, v20
  v_add_u32 v22, 65536, v20
  v_add_u32 v23, 65536, v21
  v_lshlrev_b32 v24, 4, v1
  s_and_b32 s60, s52, 1
  s_mul_i32 s60, s60, 114688
  v_add_u32 v25, s60, v24
  s_sub_u32 s60, 114688, s60
  v_add_u32 v26, s60, v24
  s_mul_i32 s70, s52, 401408
  s_lshl_b32 s60, s55, 7
  s_add_u32 s70, s70, s60
  v_mov_b32 v35, 0
  v_lshlrev_b32 v38, 3, v39
  v_add_u32 v38, 155648, v38
  v_bfe_u32 v40, v1, 3, 2
  v_and_b32 v41, 7, v1
  v_lshlrev_b32 v40, 7, v40
  v_lshl_add_u32 v40, v41, 2, v40
  v_lshl_add_u32 v40, v39, 5, v40
  s_lshl_b32 s61, s59, 9
  s_add_u32 s61, s61, 8388608
  s_waitcnt lgkmcnt(0)
  s_mov_b32 s20, s4
  s_mov_b32 s21, s5
  s_mov_b32 s24, s6
  s_mov_b32 s25, s7
  s_add_u32 m0, s66, 0
  s_lshl_b32 s62, s68, 7
  s_add_u32 s62, s62, s64
  s_mul_i32 s63, s68, 229376
  s_add_u32 s63, s63, s65
  s_add_u32 s68, s68, 1
  s_cmp_ge_u32 s68, 7
  s_cselect_b32 s68, 0, s68
  buffer_load_dwordx4 v2, s[20:23], s62 offen lds
  s_add_u32 m0, s67, 16384
  s_nop 0
  buffer_load_dwordx4 v4, s[24:27], s63 offen lds
  s_add_u32 m0, s66, 1024
  s_nop 0
  buffer_load_dwordx4 v3, s[20:23], s62 offen lds
  s_add_u32 m0, s66, 2048
  s_add_u32 s62, s62, 14336
  buffer_load_dwordx4 v2, s[20:23], s62 offen lds
  s_add_u32 m0, s67, 17408
  s_add_u32 s63, s63, 28672
  buffer_load_dwordx4 v4, s[24:27], s63 offen lds
  s_add_u32 m0, s66, 3072
  s_nop 0
  buffer_load_dwordx4 v3, s[20:23], s62 offen lds
  s_mov_b32 s40, s8
  s_mov_b32 s41, s9
  s_cmp_lg_u32 s52, 2
  s_cbranch_scc1 L_nob1
  s_mov_b32 m0, 155648
  s_lshl_b32 s60, s57, 8
  v_lshlrev_b32 v42, 2, v1
  buffer_load_dword v42, s[40:43], s60 offen lds
L_nob1:
  s_mov_b32 s32, s18
  s_mov_b32 s33, s19
  s_mov_b32 s48, s16
  s_mov_b32 s49, s17
  s_mov_b32 s28, s10
  s_mov_b32 s29, s11
  s_mov_b32 s36, s14
  s_mov_b32 s37, s15
  s_mov_b32 s44, s12
  s_mov_b32 s45, s13
  s_or_b32 s60, s55, s52
  s_cmp_lg_u32 s60, 0
  s_cbranch_scc1 L_noleader0
  buffer_load_dword v34, v40, s[32:35], s61 offen sc1
L_noleader0:
  s_add_u32 m0, s66, 24576
  s_lshl_b32 s62, s68, 7
  s_add_u32 s62, s62, s64
  s_mul_i32 s63, s68, 229376
  s_add_u32 s63, s63, s65
  s_add_u32 s68, s68, 1
  s_cmp_ge_u32 s68, 7
  s_cselect_b32 s68, 0, s68
  buffer_load_dwordx4 v2, s[20:23], s62 offen lds
  s_add_u32 m0, s67, 40960
  s_nop 0
  buffer_load_dwordx4 v4, s[24:27], s63 offen lds
  s_add_u32 m0, s66, 25600
  s_nop 0
  buffer_load_dwordx4 v3, s[20:23], s62 offen lds
  s_add_u32 m0, s66, 26624
  s_add_u32 s62, s62, 14336
  buffer_load_dwordx4 v2, s[20:23], s62 offen lds
  s_add_u32 m0, s67, 41984
  s_add_u32 s63, s63, 28672
  buffer_load_dwordx4 v4, s[24:27], s63 offen lds
  s_add_u32 m0, s66, 27648
  s_nop 0
  buffer_load_dwordx4 v3, s[20:23], s62 offen lds
  v_and_b32 v41, 7, v1
  v_min_u32 v41, 6, v41
  v_bfe_u32 v42, v1, 3, 1
  v_lshlrev_b32 v41, 2, v41
  v_lshl_add_u32 v41, v42, 5, v41
  s_lshl_b32 s60, s59, 2
  s_add_u32 s60, s60, s52
  s_lshl_b32 s60, s60, 7
  s_add_u32 s60, s60, 8388608
  v_add_u32 v29, s60, v41
  s_and_b32 s11, s52, 1
  s_cmp_eq_u32 s11, 0
  s_mov_b32 s16, 0x2a2a2a2a
  s_cselect_b32 s72, 0x55555555, s16
  s_mov_b32 s73, s72
  s_lshl_b32 s17, s11, 1
  s_sub_u32 s12, 8, s17
  s_add_u32 s13, s17, 6
  s_sub_u32 s18, 2, s17
  s_mov_b32 s4, 0
  s_mov_b32 s5, 0
  s_mov_b32 s14, s58
  s_sub_u32 s16, s14, s12
  s_cmp_ge_u32 s14, s12
  s_cselect_b32 s14, s16, s14
  s_mov_b32 s15, s58
  s_sub_u32 s16, s15, s13
  s_cmp_ge_u32 s15, s13
  s_cselect_b32 s15, s16, s15
  s_lshr_b32 s19, s14, 1
  s_lshl_b32 s19, s19, 2
  s_and_b32 s16, s14, 1
  s_add_u32 s19, s19, s16
  s_add_u32 s19, s19, s17
  s_add_u32 s14, s14, 1
  s_sub_u32 s16, s14, s12
  s_cmp_ge_u32 s14, s12
  s_cselect_b32 s14, s16, s14
  s_lshl_b32 s19, s19, 0
  s_or_b32 s4, s4, s19
  s_lshr_b32 s19, s14, 1
  s_lshl_b32 s19, s19, 2
  s_and_b32 s16, s14, 1
  s_add_u32 s19, s19, s16
  s_add_u32 s19, s19, s17
  s_add_u32 s14, s14, 1
  s_sub_u32 s16, s14, s12
  s_cmp_ge_u32 s14, s12
  s_cselect_b32 s14, s16, s14
  s_lshl_b32 s19, s19, 4
  s_or_b32 s4, s4, s19
  s_lshr_b32 s19, s14, 1
  s_lshl_b32 s19, s19, 2
  s_and_b32 s16, s14, 1
  s_add_u32 s19, s19, s16
  s_add_u32 s19, s19, s17
  s_add_u32 s14, s14, 1
  s_sub_u32 s16, s14, s12
  s_cmp_ge_u32 s14, s12
  s_cselect_b32 s14, s16, s14
  s_lshl_b32 s19, s19, 8
  s_or_b32 s4, s4, s19
  s_lshr_b32 s19, s14, 1
  s_lshl_b32 s19, s19, 2
  s_and_b32 s16, s14, 1
  s_add_u32 s19, s19, s16
  s_add_u32 s19, s19, s17
  s_add_u32 s14, s14, 1
  s_sub_u32 s16, s14, s12
  s_cmp_ge_u32 s14, s12
  s_cselect_b32 s14, s16, s14
  s_lshl_b32 s19, s19, 12
  s_or_b32 s4, s4, s19
  s_lshr_b32 s19, s14, 1
  s_lshl_b32 s19, s19, 2
  s_and_b32 s16, s14, 1
  s_add_u32 s19, s19, s16
  s_add_u32 s19, s19, s17
  s_add_u32 s14, s14, 1
  s_sub_u32 s16, s14, s12
  s_cmp_ge_u32 s14, s12
  s_cselect_b32 s14, s16, s14
  s_lshl_b32 s19, s19, 16
  s_or_b32 s4, s4, s19
  s_lshr_b32 s19, s14, 1
  s_lshl_b32 s19, s19, 2
  s_and_b32 s16, s14, 1
  s_add_u32 s19, s19, s16
  s_add_u32 s19, s19, s17
  s_add_u32 s14, s14, 1
  s_sub_u32 s16, s14, s12
  s_cmp_ge_u32 s14, s12
  s_cselect_b32 s14, s16, s14
  s_lshl_b32 s19, s19, 20
  s_or_b32 s4, s4, s19
  s_lshr_b32 s19, s14, 1
  s_lshl_b32 s19, s19, 2
  s_and_b32 s16, s14, 1
  s_add_u32 s19, s19, s16
  s_add_u32 s19, s19, s17
  s_mov_b32 s10, s19
  s_lshr_b32 s19, s15, 1
  s_lshl_b32 s19, s19, 2
  s_and_b32 s16, s15, 1
  s_add_u32 s19, s19, s16
  s_add_u32 s19, s19, s18
  s_cmp_eq_u32 s11, 0
  s_cselect_b32 s19, s10, s19
  s_add_u32 s14, s14, 1
  s_sub_u32 s16, s14, s12
  s_cmp_ge_u32 s14, s12
  s_cselect_b32 s14, s16, s14
  s_add_u32 s15, s15, s11
  s_sub_u32 s16, s15, s13
  s_cmp_ge_u32 s15, s13
  s_cselect_b32 s15, s16, s15
  s_lshl_b32 s19, s19, 24
  s_or_b32 s4, s4, s19
  s_lshr_b32 s19, s14, 1
  s_lshl_b32 s19, s19, 2
  s_and_b32 s16, s14, 1
  s_add_u32 s19, s19, s16
  s_add_u32 s19, s19, s17
  s_mov_b32 s10, s19
  s_lshr_b32 s19, s15, 1
  s_lshl_b32 s19, s19, 2
  s_and_b32 s16, s15, 1
  s_add_u32 s19, s19, s16
  s_add_u32 s19, s19, s18
  s_cmp_eq_u32 s11, 0
  s_cselect_b32 s19, s10, s19
  s_add_u32 s14, s14, 1
  s_sub_u32 s16, s14, s12
  s_cmp_ge_u32 s14, s12
  s_cselect_b32 s14, s16, s14
  s_add_u32 s15, s15, s11
  s_sub_u32 s16, s15, s13
  s_cmp_ge_u32 s15, s13
  s_cselect_b32 s15, s16, s15
  s_lshl_b32 s19, s19, 28
  s_or_b32 s4, s4, s19
  s_lshr_b32 s19, s15, 1
  s_lshl_b32 s19, s19, 2
  s_and_b32 s16, s15, 1
  s_add_u32 s19, s19, s16
  s_add_u32 s19, s19, s18
  s_add_u32 s15, s15, 1
  s_sub_u32 s16, s15, s13
  s_cmp_ge_u32 s15, s13
  s_cselect_b32 s15, s16, s15
  s_lshl_b32 s19, s19, 0
  s_or_b32 s5, s5, s19
  s_lshr_b32 s19, s15, 1
  s_lshl_b32 s19, s19, 2
  s_and_b32 s16, s15, 1
  s_add_u32 s19, s19, s16
  s_add_u32 s19, s19, s18
  s_add_u32 s15, s15, 1
  s_sub_u32 s16, s15, s13
  s_cmp_ge_u32 s15, s13
  s_cselect_b32 s15, s16, s15
  s_lshl_b32 s19, s19, 4
  s_or_b32 s5, s5, s19
  s_lshr_b32 s19, s15, 1
  s_lshl_b32 s19, s19, 2
  s_and_b32 s16, s15, 1
  s_add_u32 s19, s19, s16
  s_add_u32 s19, s19, s18
  s_add_u32 s15, s15, 1
  s_sub_u32 s16, s15, s13
  s_cmp_ge_u32 s15, s13
  s_cselect_b32 s15, s16, s15
  s_lshl_b32 s19, s19, 8
  s_or_b32 s5, s5, s19
  s_lshr_b32 s19, s15, 1
  s_lshl_b32 s19, s19, 2
  s_and_b32 s16, s15, 1
  s_add_u32 s19, s19, s16
  s_add_u32 s19, s19, s18
  s_add_u32 s15, s15, 1
  s_sub_u32 s16, s15, s13
  s_cmp_ge_u32 s15, s13
  s_cselect_b32 s15, s16, s15
  s_lshl_b32 s19, s19, 12
  s_or_b32 s5, s5, s19
  s_lshr_b32 s19, s15, 1
  s_lshl_b32 s19, s19, 2
  s_and_b32 s16, s15, 1
  s_add_u32 s19, s19, s16
  s_add_u32 s19, s19, s18
  s_add_u32 s15, s15, 1
  s_sub_u32 s16, s15, s13
  s_cmp_ge_u32 s15, s13
  s_cselect_b32 s15, s16, s15
  s_lshl_b32 s19, s19, 16
  s_or_b32 s5, s5, s19
  s_lshr_b32 s19, s15, 1
  s_lshl_b32 s19, s19, 2
  s_and_b32 s16, s15, 1
  s_add_u32 s19, s19, s16
  s_add_u32 s19, s19, s18
  s_add_u32 s15, s15, 1
  s_sub_u32 s16, s15, s13
  s_cmp_ge_u32 s15, s13
  s_cselect_b32 s15, s16, s15
  s_lshl_b32 s19, s19, 20
  s_or_b32 s5, s5, s19
  s_lshr_b32 s60, s52, 1
  s_lshl_b32 s61, s56, 1
  s_add_u32 s3, s60, s61
  s_lshl_b32 s12, s57, 1
  s_mul_i32 s13, s12, 37
  s_lshr_b32 s13, s13, 8
  s_mul_i32 s14, s13, 7
  s_sub_u32 s12, s12, s14
  s_lshl_b32 s14, s3, 2
  s_add_u32 s14, s14, s13
  s_lshl_b32 s14, s14, 7
  s_lshl_b32 s12, s12, 2
  s_add_u32 s14, s14, s12
  s_lshl_b32 s12, s11, 5
  s_add_u32 s14, s14, s12
  s_add_u32 s14, s14, 8388608
  v_mov_b32 v27, s14
  s_lshl_b32 s12, s57, 1
  s_add_u32 s12, s12, 1
  s_mul_i32 s13, s12, 37
  s_lshr_b32 s13, s13, 8
  s_mul_i32 s14, s13, 7
  s_sub_u32 s12, s12, s14
  s_lshl_b32 s14, s3, 2
  s_add_u32 s14, s14, s13
  s_lshl_b32 s14, s14, 7
  s_lshl_b32 s12, s12, 2
  s_add_u32 s14, s14, s12
  s_lshl_b32 s12, s11, 5
  s_add_u32 s14, s14, s12
  s_add_u32 s14, s14, 8388608
  v_mov_b32 v28, s14
  s_lshl_b32 s60, s56, 2
  s_add_u32 s60, s60, s52
  s_mul_i32 s60, s60, 112
  s_lshl_b32 s61, s57, 3
  s_add_u32 s60, s60, s61
  s_lshl_b32 s69, s60, 10
  v_mov_b32 v54, 0xc0135761
  v_mov_b32 v55, 0xc0135761
  v_mov_b32 v56, 0xbdd2d3e8
  v_mov_b32 v57, 0xbdd2d3e8
  v_mov_b32 v58, 0x3f800000
  v_mov_b32 v59, 0x3f800000
  s_add_u32 m0, s66, 49152
  s_lshl_b32 s62, s68, 7
  s_add_u32 s62, s62, s64
  s_mul_i32 s63, s68, 229376
  s_add_u32 s63, s63, s65
  s_add_u32 s68, s68, 1
  s_cmp_ge_u32 s68, 7
  s_cselect_b32 s68, 0, s68
  buffer_load_dwordx4 v2, s[20:23], s62 offen lds
  s_add_u32 m0, s67, 65536
  s_nop 0
  buffer_load_dwordx4 v4, s[24:27], s63 offen lds
  s_add_u32 m0, s66, 50176
  s_nop 0
  buffer_load_dwordx4 v3, s[20:23], s62 offen lds
  s_add_u32 m0, s66, 51200
  s_add_u32 s62, s62, 14336
  buffer_load_dwordx4 v2, s[20:23], s62 offen lds
  s_add_u32 m0, s67, 66560
  s_add_u32 s63, s63, 28672
  buffer_load_dwordx4 v4, s[24:27], s63 offen lds
  s_add_u32 m0, s66, 52224
  s_nop 0
  buffer_load_dwordx4 v3, s[20:23], s62 offen lds
  s_waitcnt vmcnt(12)
  s_or_b32 s60, s55, s52
  s_cmp_lg_u32 s60, 0
  s_cbranch_scc1 L_noleader
  v_and_b32 v39, 31, v1
  v_lshrrev_b32 v40, v39, v34
  v_and_b32 v40, 1, v40
  v_cmp_eq_u32 vcc, 0, v40
  s_nop 4
  s_or_b32 s60, vcc_lo, 0x80808080
  s_or_b32 s61, vcc_hi, 0x80808080
  v_mov_b32 v40, s60
  v_mov_b32 v41, s61
  s_lshl_b32 s61, s59, 3
  s_mov_b64 exec, 1
  buffer_store_dwordx2 v[40:41], v35, s[48:51], s61 offen sc1
  s_mov_b64 exec, -1
L_noleader:
  s_barrier
  ds_read_b64 v[224:225], v38 offset:0
  ds_read_b64 v[226:227], v38 offset:16
  ds_read_b64 v[228:229], v38 offset:32
  ds_read_b64 v[230:231], v38 offset:48
  ds_read_b64 v[232:233], v38 offset:64
  ds_read_b64 v[234:235], v38 offset:80
  ds_read_b64 v[236:237], v38 offset:96
  ds_read_b64 v[238:239], v38 offset:112
  ds_read_b64 v[240:241], v38 offset:128
  ds_read_b64 v[242:243], v38 offset:144
  ds_read_b64 v[244:245], v38 offset:160
  ds_read_b64 v[246:247], v38 offset:176
  ds_read_b64 v[248:249], v38 offset:192
  ds_read_b64 v[250:251], v38 offset:208
  ds_read_b64 v[252:253], v38 offset:224
  ds_read_b64 v[254:255], v38 offset:240
  s_waitcnt lgkmcnt(8)
  ds_read_b128 a[128:131], v6 offset:0
  ds_read_b64_tr_b16 v[192:193], v14 offset:0
  ds_read_b64_tr_b16 v[194:195], v14 offset:512
  ds_read_b64_tr_b16 v[196:197], v15 offset:0
  ds_read_b64_tr_b16 v[198:199], v15 offset:512
  v_lshlrev_b32 v128, 16, v224
  v_and_b32 v129, 0xffff0000, v224
  v_lshlrev_b32 v130, 16, v225
  v_and_b32 v131, 0xffff0000, v225
  v_lshlrev_b32 v132, 16, v226
  v_and_b32 v133, 0xffff0000, v226
  v_lshlrev_b32 v134, 16, v227
  v_and_b32 v135, 0xffff0000, v227
  v_lshlrev_b32 v136, 16, v228
  v_and_b32 v137, 0xffff0000, v228
  v_lshlrev_b32 v138, 16, v229
  v_and_b32 v139, 0xffff0000, v229
  v_lshlrev_b32 v140, 16, v230
  v_and_b32 v141, 0xffff0000, v230
  v_lshlrev_b32 v142, 16, v231
  v_and_b32 v143, 0xffff0000, v231
  v_lshlrev_b32 v144, 16, v232
  v_and_b32 v145, 0xffff0000, v232
  v_lshlrev_b32 v146, 16, v233
  v_and_b32 v147, 0xffff0000, v233
  v_lshlrev_b32 v148, 16, v234
  v_and_b32 v149, 0xffff0000, v234
  v_lshlrev_b32 v150, 16, v235
  v_and_b32 v151, 0xffff0000, v235
  v_lshlrev_b32 v152, 16, v236
  v_and_b32 v153, 0xffff0000, v236
  v_lshlrev_b32 v154, 16, v237
  v_and_b32 v155, 0xffff0000, v237
  v_lshlrev_b32 v156, 16, v238
  v_and_b32 v157, 0xffff0000, v238
  v_lshlrev_b32 v158, 16, v239
  v_and_b32 v159, 0xffff0000, v239
  ds_read_b128 a[132:135], v7 offset:0
  ds_read_b64_tr_b16 v[200:201], v14 offset:2048
  ds_read_b64_tr_b16 v[202:203], v14 offset:2560
  ds_read_b64_tr_b16 v[204:205], v15 offset:2048
  ds_read_b64_tr_b16 v[206:207], v15 offset:2560
  s_waitcnt lgkmcnt(5)
  v_mfma_f32_32x32x16_bf16 v[64:79], v[192:195], a[128:131], v[128:143]
  ds_read_b128 a[136:139], v8 offset:0
  ds_read_b64_tr_b16 v[208:209], v14 offset:4096
  ds_read_b64_tr_b16 v[210:211], v14 offset:4608
  s_add_u32 m0, s66, 73728
  s_lshl_b32 s62, s68, 7
  s_add_u32 s62, s62, s64
  s_mul_i32 s63, s68, 229376
  s_add_u32 s63, s63, s65
  s_add_u32 s68, s68, 1
  s_cmp_ge_u32 s68, 7
  s_cselect_b32 s68, 0, s68
  buffer_load_dwordx4 v2, s[20:23], s62 offen lds
  v_mfma_f32_32x32x16_bf16 v[80:95], v[196:199], a[128:131], v[144:159]
  ds_read_b64_tr_b16 v[212:213], v15 offset:4096
  ds_read_b64_tr_b16 v[214:215], v15 offset:4608
  s_add_u32 m0, s67, 90112
  s_nop 0
  buffer_load_dwordx4 v4, s[24:27], s63 offen lds
  s_waitcnt lgkmcnt(5)
  v_mfma_f32_32x32x16_bf16 v[64:79], v[200:203], a[132:135], v[64:79]
  ds_read_b128 a[140:143], v9 offset:0
  ds_read_b64_tr_b16 v[216:217], v14 offset:6144
  ds_read_b64_tr_b16 v[218:219], v14 offset:6656
  s_add_u32 m0, s66, 74752
  s_nop 0
  buffer_load_dwordx4 v3, s[20:23], s62 offen lds
  v_mfma_f32_32x32x16_bf16 v[80:95], v[204:207], a[132:135], v[80:95]
  ds_read_b64_tr_b16 v[220:221], v15 offset:6144
  ds_read_b64_tr_b16 v[222:223], v15 offset:6656
  s_add_u32 m0, s66, 75776
  s_add_u32 s62, s62, 14336
  buffer_load_dwordx4 v2, s[20:23], s62 offen lds
  s_waitcnt lgkmcnt(5)
  v_mfma_f32_32x32x16_bf16 v[64:79], v[208:211], a[136:139], v[64:79]
  s_add_u32 m0, s67, 91136
  s_add_u32 s63, s63, 28672
  buffer_load_dwordx4 v4, s[24:27], s63 offen lds
  s_add_u32 m0, s66, 76800
  s_nop 0
  buffer_load_dwordx4 v3, s[20:23], s62 offen lds
  v_mfma_f32_32x32x16_bf16 v[80:95], v[212:215], a[136:139], v[80:95]
  v_lshlrev_b32 v160, 16, v240
  v_and_b32 v161, 0xffff0000, v240
  v_lshlrev_b32 v162, 16, v241
  v_and_b32 v163, 0xffff0000, v241
  v_lshlrev_b32 v164, 16, v242
  v_and_b32 v165, 0xffff0000, v242
  v_lshlrev_b32 v166, 16, v243
  v_and_b32 v167, 0xffff0000, v243
  v_lshlrev_b32 v168, 16, v244
  v_and_b32 v169, 0xffff0000, v244
  v_lshlrev_b32 v170, 16, v245
  v_and_b32 v171, 0xffff0000, v245
  v_lshlrev_b32 v172, 16, v246
  v_and_b32 v173, 0xffff0000, v246
  v_lshlrev_b32 v174, 16, v247
  v_and_b32 v175, 0xffff0000, v247
  v_lshlrev_b32 v176, 16, v248
  v_and_b32 v177, 0xffff0000, v248
  v_lshlrev_b32 v178, 16, v249
  v_and_b32 v179, 0xffff0000, v249
  v_lshlrev_b32 v180, 16, v250
  v_and_b32 v181, 0xffff0000, v250
  v_lshlrev_b32 v182, 16, v251
  v_and_b32 v183, 0xffff0000, v251
  v_lshlrev_b32 v184, 16, v252
  v_and_b32 v185, 0xffff0000, v252
  v_lshlrev_b32 v186, 16, v253
  v_and_b32 v187, 0xffff0000, v253
  v_lshlrev_b32 v188, 16, v254
  v_and_b32 v189, 0xffff0000, v254
  v_lshlrev_b32 v190, 16, v255
  v_and_b32 v191, 0xffff0000, v255
  s_waitcnt vmcnt(12) lgkmcnt(0)
  s_barrier
  v_mfma_f32_32x32x16_bf16 v[64:79], v[216:219], a[140:143], v[64:79]
  ds_read_b128 a[144:147], v6 offset:24576
  ds_read_b64_tr_b16 v[192:193], v14 offset:24576
  ds_read_b64_tr_b16 v[194:195], v14 offset:25088
  ds_read_b64_tr_b16 v[196:197], v15 offset:24576
  ds_read_b64_tr_b16 v[198:199], v15 offset:25088
  v_mfma_f32_32x32x16_bf16 v[80:95], v[220:223], a[140:143], v[80:95]
  ds_read_b128 a[148:151], v7 offset:24576
  ds_read_b64_tr_b16 v[200:201], v14 offset:26624
  ds_read_b64_tr_b16 v[202:203], v14 offset:27136
  ds_read_b64_tr_b16 v[204:205], v15 offset:26624
  ds_read_b64_tr_b16 v[206:207], v15 offset:27136
  s_waitcnt lgkmcnt(5)
  v_mfma_f32_32x32x16_bf16 v[64:79], v[192:195], a[144:147], v[64:79]
  ds_read_b128 a[152:155], v8 offset:24576
  ds_read_b64_tr_b16 v[208:209], v14 offset:28672
  ds_read_b64_tr_b16 v[210:211], v14 offset:29184
  s_add_u32 m0, s66, 0
  s_lshl_b32 s62, s68, 7
  s_add_u32 s62, s62, s64
  s_mul_i32 s63, s68, 229376
  s_add_u32 s63, s63, s65
  s_add_u32 s68, s68, 1
  s_cmp_ge_u32 s68, 7
  s_cselect_b32 s68, 0, s68
  buffer_load_dwordx4 v2, s[20:23], s62 offen lds
  v_mfma_f32_32x32x16_bf16 v[80:95], v[196:199], a[144:147], v[80:95]
  ds_read_b64_tr_b16 v[212:213], v15 offset:28672
  ds_read_b64_tr_b16 v[214:215], v15 offset:29184
  s_add_u32 m0, s67, 16384
  s_nop 0
  buffer_load_dwordx4 v4, s[24:27], s63 offen lds
  s_waitcnt lgkmcnt(5)
  v_mfma_f32_32x32x16_bf16 v[64:79], v[200:203], a[148:151], v[64:79]
  ds_read_b128 a[156:159], v9 offset:24576
  ds_read_b64_tr_b16 v[216:217], v14 offset:30720
  ds_read_b64_tr_b16 v[218:219], v14 offset:31232
  s_add_u32 m0, s66, 1024
  s_nop 0
  buffer_load_dwordx4 v3, s[20:23], s62 offen lds
  v_mfma_f32_32x32x16_bf16 v[80:95], v[204:207], a[148:151], v[80:95]
  ds_read_b64_tr_b16 v[220:221], v15 offset:30720
  ds_read_b64_tr_b16 v[222:223], v15 offset:31232
  s_add_u32 m0, s66, 2048
  s_add_u32 s62, s62, 14336
  buffer_load_dwordx4 v2, s[20:23], s62 offen lds
  s_waitcnt lgkmcnt(5)
  v_mfma_f32_32x32x16_bf16 v[64:79], v[208:211], a[152:155], v[64:79]
  s_add_u32 m0, s67, 17408
  s_add_u32 s63, s63, 28672
  buffer_load_dwordx4 v4, s[24:27], s63 offen lds
  s_add_u32 m0, s66, 3072
  s_nop 0
  buffer_load_dwordx4 v3, s[20:23], s62 offen lds
  v_mfma_f32_32x32x16_bf16 v[80:95], v[212:215], a[152:155], v[80:95]
  s_waitcnt vmcnt(12) lgkmcnt(0)
  s_barrier
  v_mfma_f32_32x32x16_bf16 v[64:79], v[216:219], a[156:159], v[64:79]
  ds_read_b128 a[160:163], v10 offset:0
  ds_read_b64_tr_b16 v[192:193], v16 offset:0
  ds_read_b64_tr_b16 v[194:195], v16 offset:512
  ds_read_b64_tr_b16 v[196:197], v17 offset:0
  ds_read_b64_tr_b16 v[198:199], v17 offset:512
  v_mfma_f32_32x32x16_bf16 v[80:95], v[220:223], a[156:159], v[80:95]
  ds_read_b128 a[164:167], v11 offset:0
  ds_read_b64_tr_b16 v[200:201], v16 offset:2048
  ds_read_b64_tr_b16 v[202:203], v16 offset:2560
  ds_read_b64_tr_b16 v[204:205], v17 offset:2048
  ds_read_b64_tr_b16 v[206:207], v17 offset:2560
  s_waitcnt lgkmcnt(5)
  v_mfma_f32_32x32x16_bf16 v[64:79], v[192:195], a[160:163], v[64:79]
  ds_read_b128 a[168:171], v12 offset:0
  ds_read_b64_tr_b16 v[208:209], v16 offset:4096
  ds_read_b64_tr_b16 v[210:211], v16 offset:4608
  s_add_u32 m0, s66, 24576
  s_lshl_b32 s62, s68, 7
  s_add_u32 s62, s62, s64
  s_mul_i32 s63, s68, 229376
  s_add_u32 s63, s63, s65
  s_add_u32 s68, s68, 1
  s_cmp_ge_u32 s68, 7
  s_cselect_b32 s68, 0, s68
  buffer_load_dwordx4 v2, s[20:23], s62 offen lds
  v_mfma_f32_32x32x16_bf16 v[80:95], v[196:199], a[160:163], v[80:95]
  ds_read_b64_tr_b16 v[212:213], v17 offset:4096
  ds_read_b64_tr_b16 v[214:215], v17 offset:4608
  s_add_u32 m0, s67, 40960
  s_nop 0
  buffer_load_dwordx4 v4, s[24:27], s63 offen lds
  s_waitcnt lgkmcnt(5)
  v_mfma_f32_32x32x16_bf16 v[64:79], v[200:203], a[164:167], v[64:79]
  ds_read_b128 a[172:175], v13 offset:0
  ds_read_b64_tr_b16 v[216:217], v16 offset:6144
  ds_read_b64_tr_b16 v[218:219], v16 offset:6656
  s_add_u32 m0, s66, 25600
  s_nop 0
  buffer_load_dwordx4 v3, s[20:23], s62 offen lds
  v_mfma_f32_32x32x16_bf16 v[80:95], v[204:207], a[164:167], v[80:95]
  ds_read_b64_tr_b16 v[220:221], v17 offset:6144
  ds_read_b64_tr_b16 v[222:223], v17 offset:6656
  s_add_u32 m0, s66, 26624
  s_add_u32 s62, s62, 14336
  buffer_load_dwordx4 v2, s[20:23], s62 offen lds
  s_waitcnt lgkmcnt(5)
  v_mfma_f32_32x32x16_bf16 v[64:79], v[208:211], a[168:171], v[64:79]
  s_add_u32 m0, s67, 41984
  s_add_u32 s63, s63, 28672
  buffer_load_dwordx4 v4, s[24:27], s63 offen lds
  s_add_u32 m0, s66, 27648
  s_nop 0
  buffer_load_dwordx4 v3, s[20:23], s62 offen lds
  v_mfma_f32_32x32x16_bf16 v[80:95], v[212:215], a[168:171], v[80:95]
  s_waitcnt vmcnt(12) lgkmcnt(0)
  s_barrier
  v_mfma_f32_32x32x16_bf16 v[64:79], v[216:219], a[172:175], v[64:79]
  ds_read_b128 a[176:179], v10 offset:24576
  ds_read_b64_tr_b16 v[192:193], v16 offset:24576
  ds_read_b64_tr_b16 v[194:195], v16 offset:25088
  ds_read_b64_tr_b16 v[196:197], v17 offset:24576
  ds_read_b64_tr_b16 v[198:199], v17 offset:25088
  v_mfma_f32_32x32x16_bf16 v[80:95], v[220:223], a[172:175], v[80:95]
  ds_read_b128 a[180:183], v11 offset:24576
  ds_read_b64_tr_b16 v[200:201], v16 offset:26624
  ds_read_b64_tr_b16 v[202:203], v16 offset:27136
  ds_read_b64_tr_b16 v[204:205], v17 offset:26624
  ds_read_b64_tr_b16 v[206:207], v17 offset:27136
  s_waitcnt lgkmcnt(5)
  v_mfma_f32_32x32x16_bf16 v[64:79], v[192:195], a[176:179], v[64:79]
  ds_read_b128 a[184:187], v12 offset:24576
  ds_read_b64_tr_b16 v[208:209], v16 offset:28672
  ds_read_b64_tr_b16 v[210:211], v16 offset:29184
  s_add_u32 m0, s66, 49152
  s_lshl_b32 s62, s68, 7
  s_add_u32 s62, s62, s64
  s_mul_i32 s63, s68, 229376
  s_add_u32 s63, s63, s65
  s_add_u32 s68, s68, 1
  s_cmp_ge_u32 s68, 7
  s_cselect_b32 s68, 0, s68
  buffer_load_dwordx4 v2, s[20:23], s62 offen lds
  v_mfma_f32_32x32x16_bf16 v[80:95], v[196:199], a[176:179], v[80:95]
  ds_read_b64_tr_b16 v[212:213], v17 offset:28672
  ds_read_b64_tr_b16 v[214:215], v17 offset:29184
  s_add_u32 m0, s67, 65536
  s_nop 0
  buffer_load_dwordx4 v4, s[24:27], s63 offen lds
  s_waitcnt lgkmcnt(5)
  v_mfma_f32_32x32x16_bf16 v[64:79], v[200:203], a[180:183], v[64:79]
  ds_read_b128 a[188:191], v13 offset:24576
  ds_read_b64_tr_b16 v[216:217], v16 offset:30720
  ds_read_b64_tr_b16 v[218:219], v16 offset:31232
  s_add_u32 m0, s66, 50176
  s_nop 0
  buffer_load_dwordx4 v3, s[20:23], s62 offen lds
  v_mfma_f32_32x32x16_bf16 v[80:95], v[204:207], a[180:183], v[80:95]
  ds_read_b64_tr_b16 v[220:221], v17 offset:30720
  ds_read_b64_tr_b16 v[222:223], v17 offset:31232
  s_add_u32 m0, s66, 51200
  s_add_u32 s62, s62, 14336
  buffer_load_dwordx4 v2, s[20:23], s62 offen lds
  s_waitcnt lgkmcnt(5)
  v_mfma_f32_32x32x16_bf16 v[64:79], v[208:211], a[184:187], v[64:79]
  s_add_u32 m0, s67, 66560
  s_add_u32 s63, s63, 28672
  buffer_load_dwordx4 v4, s[24:27], s63 offen lds
  s_add_u32 m0, s66, 52224
  s_nop 0
  buffer_load_dwordx4 v3, s[20:23], s62 offen lds
  v_mfma_f32_32x32x16_bf16 v[80:95], v[212:215], a[184:187], v[80:95]
  s_mov_b32 s68, s58
  s_add_u32 m0, s67, 98304
  s_mul_i32 s63, s68, 229376
  s_add_u32 s63, s63, s65
  s_add_u32 s63, s63, 128
  s_add_u32 s68, s68, 1
  s_cmp_ge_u32 s68, 7
  s_cselect_b32 s68, 0, s68
  buffer_load_dwordx4 v4, s[24:27], s63 offen lds
  s_waitcnt vmcnt(13) lgkmcnt(0)
  s_barrier
  v_mfma_f32_32x32x16_bf16 v[64:79], v[216:219], a[188:191], v[64:79]
  ds_read_b128 a[192:195], v6 offset:0
  ds_read_b64_tr_b16 v[192:193], v14 offset:0
  ds_read_b64_tr_b16 v[194:195], v14 offset:512
  ds_read_b64_tr_b16 v[196:197], v15 offset:0
  ds_read_b64_tr_b16 v[198:199], v15 offset:512
  v_mfma_f32_32x32x16_bf16 v[80:95], v[220:223], a[188:191], v[80:95]
  ds_read_b128 a[196:199], v7 offset:0
  ds_read_b64_tr_b16 v[200:201], v14 offset:2048
  ds_read_b64_tr_b16 v[202:203], v14 offset:2560
  ds_read_b64_tr_b16 v[204:205], v15 offset:2048
  ds_read_b64_tr_b16 v[206:207], v15 offset:2560
  s_waitcnt lgkmcnt(5)
  v_mfma_f32_32x32x16_bf16 v[64:79], v[192:195], a[192:195], v[64:79]
  ds_read_b128 a[200:203], v8 offset:0
  ds_read_b64_tr_b16 v[208:209], v14 offset:4096
  ds_read_b64_tr_b16 v[210:211], v14 offset:4608
  s_add_u32 m0, s67, 99328
  s_add_u32 s63, s63, 28672
  buffer_load_dwordx4 v4, s[24:27], s63 offen lds
  v_mfma_f32_32x32x16_bf16 v[80:95], v[196:199], a[192:195], v[80:95]
  ds_read_b64_tr_b16 v[212:213], v15 offset:4096
  ds_read_b64_tr_b16 v[214:215], v15 offset:4608
  s_add_u32 m0, s67, 106496
  s_mul_i32 s63, s68, 229376
  s_add_u32 s63, s63, s65
  s_add_u32 s63, s63, 128
  s_add_u32 s68, s68, 1
  s_cmp_ge_u32 s68, 7
  s_cselect_b32 s68, 0, s68
  buffer_load_dwordx4 v4, s[24:27], s63 offen lds
  s_waitcnt lgkmcnt(5)
  v_mfma_f32_32x32x16_bf16 v[64:79], v[200:203], a[196:199], v[64:79]
  ds_read_b128 a[204:207], v9 offset:0
  ds_read_b64_tr_b16 v[216:217], v14 offset:6144
  ds_read_b64_tr_b16 v[218:219], v14 offset:6656
  s_add_u32 m0, s67, 107520
  s_add_u32 s63, s63, 28672
  buffer_load_dwordx4 v4, s[24:27], s63 offen lds
  v_mfma_f32_32x32x16_bf16 v[80:95], v[204:207], a[196:199], v[80:95]
  ds_read_b64_tr_b16 v[220:221], v15 offset:6144
  ds_read_b64_tr_b16 v[222:223], v15 offset:6656
  s_add_u32 m0, s67, 114688
  s_mul_i32 s63, s68, 229376
  s_add_u32 s63, s63, s65
  s_add_u32 s63, s63, 128
  s_add_u32 s68, s68, 1
  s_cmp_ge_u32 s68, 7
  s_cselect_b32 s68, 0, s68
  buffer_load_dwordx4 v4, s[24:27], s63 offen lds
  s_waitcnt lgkmcnt(5)
  v_mfma_f32_32x32x16_bf16 v[64:79], v[208:211], a[200:203], v[64:79]
  s_add_u32 m0, s67, 115712
  s_add_u32 s63, s63, 28672
  buffer_load_dwordx4 v4, s[24:27], s63 offen lds
  s_add_u32 m0, s67, 122880
  s_mul_i32 s63, s68, 229376
  s_add_u32 s63, s63, s65
  s_add_u32 s63, s63, 128
  s_add_u32 s68, s68, 1
  s_cmp_ge_u32 s68, 7
  s_cselect_b32 s68, 0, s68
  buffer_load_dwordx4 v4, s[24:27], s63 offen lds
  v_mfma_f32_32x32x16_bf16 v[80:95], v[212:215], a[200:203], v[80:95]
  s_add_u32 m0, s67, 123904
  s_add_u32 s63, s63, 28672
  buffer_load_dwordx4 v4, s[24:27], s63 offen lds
  s_add_u32 m0, s67, 131072
  s_mul_i32 s63, s68, 229376
  s_add_u32 s63, s63, s65
  s_add_u32 s63, s63, 128
  s_add_u32 s68, s68, 1
  s_cmp_ge_u32 s68, 7
  s_cselect_b32 s68, 0, s68
  buffer_load_dwordx4 v4, s[24:27], s63 offen lds
  s_lshl_b32 s60, s3, 3
  s_and_b32 s61, s52, 1
  s_lshl_b32 s61, s61, 2
  s_add_u32 s60, s60, s61
  s_lshl_b32 s61, s59, 3
  buffer_load_dword v30, v35, s[48:51], s60 offen sc1
  buffer_load_dwordx2 v[32:33], v35, s[48:51], s61 offen sc1
  s_waitcnt vmcnt(17) lgkmcnt(0)
  s_barrier
  v_mfma_f32_32x32x16_bf16 v[64:79], v[216:219], a[204:207], v[64:79]
  ds_read_b128 a[208:211], v6 offset:24576
  ds_read_b64_tr_b16 v[192:193], v14 offset:24576
  ds_read_b64_tr_b16 v[194:195], v14 offset:25088
  ds_read_b64_tr_b16 v[196:197], v15 offset:24576
  ds_read_b64_tr_b16 v[198:199], v15 offset:25088
  v_mfma_f32_32x32x16_bf16 v[80:95], v[220:223], a[204:207], v[80:95]
  ds_read_b128 a[212:215], v7 offset:24576
  ds_read_b64_tr_b16 v[200:201], v14 offset:26624
  ds_read_b64_tr_b16 v[202:203], v14 offset:27136
  ds_read_b64_tr_b16 v[204:205], v15 offset:26624
  ds_read_b64_tr_b16 v[206:207], v15 offset:27136
  s_waitcnt lgkmcnt(5)
  v_mfma_f32_32x32x16_bf16 v[64:79], v[192:195], a[208:211], v[64:79]
  ds_read_b128 a[216:219], v8 offset:24576
  ds_read_b64_tr_b16 v[208:209], v14 offset:28672
  ds_read_b64_tr_b16 v[210:211], v14 offset:29184
  s_add_u32 m0, s67, 132096
  s_add_u32 s63, s63, 28672
  buffer_load_dwordx4 v4, s[24:27], s63 offen lds
  v_mfma_f32_32x32x16_bf16 v[80:95], v[196:199], a[208:211], v[80:95]
  ds_read_b64_tr_b16 v[212:213], v15 offset:28672
  ds_read_b64_tr_b16 v[214:215], v15 offset:29184
  s_add_u32 m0, s67, 139264
  s_mul_i32 s63, s68, 229376
  s_add_u32 s63, s63, s65
  s_add_u32 s63, s63, 128
  s_add_u32 s68, s68, 1
  s_cmp_ge_u32 s68, 7
  s_cselect_b32 s68, 0, s68
  buffer_load_dwordx4 v4, s[24:27], s63 offen lds
  s_waitcnt lgkmcnt(5)
  v_mfma_f32_32x32x16_bf16 v[64:79], v[200:203], a[212:215], v[64:79]
  ds_read_b128 a[220:223], v9 offset:24576
  ds_read_b64_tr_b16 v[216:217], v14 offset:30720
  ds_read_b64_tr_b16 v[218:219], v14 offset:31232
  s_add_u32 m0, s67, 140288
  s_add_u32 s63, s63, 28672
  buffer_load_dwordx4 v4, s[24:27], s63 offen lds
  v_mfma_f32_32x32x16_bf16 v[80:95], v[204:207], a[212:215], v[80:95]
  ds_read_b64_tr_b16 v[220:221], v15 offset:30720
  ds_read_b64_tr_b16 v[222:223], v15 offset:31232
  s_add_u32 m0, s67, 147456
  s_mul_i32 s63, s68, 229376
  s_add_u32 s63, s63, s65
  s_add_u32 s63, s63, 128
  s_add_u32 s68, s68, 1
  s_cmp_ge_u32 s68, 7
  s_cselect_b32 s68, 0, s68
  buffer_load_dwordx4 v4, s[24:27], s63 offen lds
  s_waitcnt lgkmcnt(5)
  v_mfma_f32_32x32x16_bf16 v[64:79], v[208:211], a[216:219], v[64:79]
  s_add_u32 m0, s67, 148480
  s_add_u32 s63, s63, 28672
  buffer_load_dwordx4 v4, s[24:27], s63 offen lds
  v_mfma_f32_32x32x16_bf16 v[80:95], v[212:215], a[216:219], v[80:95]
  v_lshrrev_b32 v39, 5, v1
  v_lshlrev_b32 v39, 3, v39
  s_lshr_b32 s60, s52, 1
  s_lshl_b32 s60, s60, 6
  s_lshl_b32 s61, s55, 7
  s_add_u32 s60, s60, s61
  buffer_load_dwordx2 a[240:241], v39, s[44:47], s60 offen offset:0
  buffer_load_dwordx2 a[242:243], v39, s[44:47], s60 offen offset:16
  buffer_load_dwordx2 a[244:245], v39, s[44:47], s60 offen offset:32
  buffer_load_dwordx2 a[246:247], v39, s[44:47], s60 offen offset:48
  s_waitcnt vmcnt(20) lgkmcnt(0)
  s_barrier
  v_mfma_f32_32x32x16_bf16 v[64:79], v[216:219], a[220:223], v[64:79]
  ds_read_b128 a[224:227], v10 offset:0
  ds_read_b64_tr_b16 v[192:193], v16 offset:0
  ds_read_b64_tr_b16 v[194:195], v16 offset:512
  ds_read_b64_tr_b16 v[196:197], v17 offset:0
  ds_read_b64_tr_b16 v[198:199], v17 offset:512
  v_mfma_f32_32x32x16_bf16 v[80:95], v[220:223], a[220:223], v[80:95]
  ds_read_b128 a[228:231], v11 offset:0
  ds_read_b64_tr_b16 v[200:201], v16 offset:2048
  ds_read_b64_tr_b16 v[202:203], v16 offset:2560
  ds_read_b64_tr_b16 v[204:205], v17 offset:2048
  ds_read_b64_tr_b16 v[206:207], v17 offset:2560
  s_waitcnt lgkmcnt(5)
  v_mfma_f32_32x32x16_bf16 v[64:79], v[192:195], a[224:227], v[64:79]
  ds_read_b128 a[232:235], v12 offset:0
  ds_read_b64_tr_b16 v[208:209], v16 offset:4096
  ds_read_b64_tr_b16 v[210:211], v16 offset:4608
  v_mfma_f32_32x32x16_bf16 v[80:95], v[196:199], a[224:227], v[80:95]
  ds_read_b64_tr_b16 v[212:213], v17 offset:4096
  ds_read_b64_tr_b16 v[214:215], v17 offset:4608
  s_waitcnt lgkmcnt(5)
  v_mfma_f32_32x32x16_bf16 v[64:79], v[200:203], a[228:231], v[64:79]
  ds_read_b128 a[236:239], v13 offset:0
  ds_read_b64_tr_b16 v[216:217], v16 offset:6144
  ds_read_b64_tr_b16 v[218:219], v16 offset:6656
  v_mfma_f32_32x32x16_bf16 v[80:95], v[204:207], a[228:231], v[80:95]
  ds_read_b64_tr_b16 v[220:221], v17 offset:6144
  ds_read_b64_tr_b16 v[222:223], v17 offset:6656
  s_waitcnt lgkmcnt(5)
  v_mfma_f32_32x32x16_bf16 v[64:79], v[208:211], a[232:235], v[64:79]
  v_mfma_f32_32x32x16_bf16 v[80:95], v[212:215], a[232:235], v[80:95]
  s_waitcnt vmcnt(16) lgkmcnt(0)
  s_barrier
  v_mfma_f32_32x32x16_bf16 v[64:79], v[216:219], a[236:239], v[64:79]
  ds_read_b64_tr_b16 v[192:193], v18 offset:0
  ds_read_b64_tr_b16 v[194:195], v18 offset:512
  ds_read_b64_tr_b16 v[196:197], v19 offset:0
  ds_read_b64_tr_b16 v[198:199], v19 offset:512
  v_mfma_f32_32x32x16_bf16 v[80:95], v[220:223], a[236:239], v[80:95]
  ds_read_b64_tr_b16 v[200:201], v18 offset:2048
  ds_read_b64_tr_b16 v[202:203], v18 offset:2560
  ds_read_b64_tr_b16 v[204:205], v19 offset:2048
  ds_read_b64_tr_b16 v[206:207], v19 offset:2560
  s_waitcnt lgkmcnt(4)
  v_mfma_f32_32x32x16_bf16 v[96:111], v[192:195], a[128:131], v[160:175]
  ds_read_b64_tr_b16 v[208:209], v18 offset:4096
  ds_read_b64_tr_b16 v[210:211], v18 offset:4608
  s_add_u32 m0, s71, 0
  s_bfe_u32 s62, s4, 262144
  s_mul_i32 s62, s62, 28672
  s_add_u32 s62, s62, s70
  buffer_load_dwordx4 v5, s[28:31], s62 offen offset:0 lds
  v_mfma_f32_32x32x16_bf16 v[112:127], v[196:199], a[128:131], v[176:191]
  ds_read_b64_tr_b16 v[212:213], v19 offset:4096
  ds_read_b64_tr_b16 v[214:215], v19 offset:4608
  s_waitcnt lgkmcnt(4)
  v_mfma_f32_32x32x16_bf16 v[96:111], v[200:203], a[132:135], v[96:111]
  ds_read_b64_tr_b16 v[216:217], v18 offset:6144
  ds_read_b64_tr_b16 v[218:219], v18 offset:6656
  v_mul_f32 v38, v64, v64
  v_mul_f32 v39, v65, v65
  v_mul_f32 v40, v66, v66
  v_mul_f32 v41, v67, v67
  v_mul_f32 v42, v68, v68
  v_mul_f32 v43, v69, v69
  buffer_load_dwordx4 v60, s[28:31], s62 offen offset:1024 lds
  v_mfma_f32_32x32x16_bf16 v[112:127], v[204:207], a[132:135], v[112:127]
  ds_read_b64_tr_b16 v[220:221], v19 offset:6144
  ds_read_b64_tr_b16 v[222:223], v19 offset:6656
  v_mul_f32 v44, v70, v70
  v_mul_f32 v45, v71, v71
  v_fmaak_f32 v38, v38, v56, 0xc0135761
  v_fmaak_f32 v39, v39, v56, 0xc0135761
  v_fmaak_f32 v40, v40, v56, 0xc0135761
  v_fmaak_f32 v41, v41, v56, 0xc0135761
  s_waitcnt lgkmcnt(4)
  v_mfma_f32_32x32x16_bf16 v[96:111], v[208:211], a[136:139], v[96:111]
  ds_read_b64_tr_b16 v[192:193], v18 offset:8192
  ds_read_b64_tr_b16 v[194:195], v18 offset:8704
  v_fmaak_f32 v42, v42, v56, 0xc0135761
  v_fmaak_f32 v43, v43, v56, 0xc0135761
  v_fmaak_f32 v44, v44, v56, 0xc0135761
  v_fmaak_f32 v45, v45, v56, 0xc0135761
  v_mul_f32 v38, v38, v64
  v_mul_f32 v39, v39, v65
  buffer_load_dwordx4 v61, s[28:31], s62 offen offset:2048 lds
  v_mfma_f32_32x32x16_bf16 v[112:127], v[212:215], a[136:139], v[112:127]
  ds_read_b64_tr_b16 v[196:197], v19 offset:8192
  ds_read_b64_tr_b16 v[198:199], v19 offset:8704
  v_mul_f32 v40, v40, v66
  v_mul_f32 v41, v41, v67
  v_mul_f32 v42, v42, v68
  v_mul_f32 v43, v43, v69
  v_mul_f32 v44, v44, v70
  v_mul_f32 v45, v45, v71
  s_waitcnt lgkmcnt(4)
  v_mfma_f32_32x32x16_bf16 v[96:111], v[216:219], a[140:143], v[96:111]
  ds_read_b64_tr_b16 v[200:201], v18 offset:10240
  ds_read_b64_tr_b16 v[202:203], v18 offset:10752
  v_exp_f32 v38, v38
  v_exp_f32 v39, v39
  v_exp_f32 v40, v40
  buffer_load_dwordx4 v62, s[28:31], s62 offen offset:3072 lds
  v_mfma_f32_32x32x16_bf16 v[112:127], v[220:223], a[140:143], v[112:127]
  ds_read_b64_tr_b16 v[204:205], v19 offset:10240
  ds_read_b64_tr_b16 v[206:207], v19 offset:10752
  v_exp_f32 v41, v41
  v_exp_f32 v42, v42
  v_exp_f32 v43, v43
  s_waitcnt lgkmcnt(4)
  v_mfma_f32_32x32x16_bf16 v[96:111], v[192:195], a[144:147], v[96:111]
  ds_read_b64_tr_b16 v[208:209], v18 offset:12288
  ds_read_b64_tr_b16 v[210:211], v18 offset:12800
  v_exp_f32 v44, v44
  v_exp_f32 v45, v45
  v_add_f32 v38, 1.0, v38
  v_mfma_f32_32x32x16_bf16 v[112:127], v[196:199], a[144:147], v[112:127]
  ds_read_b64_tr_b16 v[212:213], v19 offset:12288
  ds_read_b64_tr_b16 v[214:215], v19 offset:12800
  v_add_f32 v39, 1.0, v39
  v_add_f32 v40, 1.0, v40
  v_add_f32 v41, 1.0, v41
  v_add_f32 v42, 1.0, v42
  v_add_f32 v43, 1.0, v43
  v_add_f32 v44, 1.0, v44
  s_add_u32 m0, s71, 4096
  s_bfe_u32 s62, s4, 262148
  s_mul_i32 s62, s62, 28672
  s_add_u32 s62, s62, s70
  buffer_load_dwordx4 v5, s[28:31], s62 offen offset:0 lds
  s_waitcnt lgkmcnt(4)
  v_mfma_f32_32x32x16_bf16 v[96:111], v[200:203], a[148:151], v[96:111]
  ds_read_b64_tr_b16 v[216:217], v18 offset:14336
  ds_read_b64_tr_b16 v[218:219], v18 offset:14848
  v_add_f32 v45, 1.0, v45
  v_rcp_f32 v38, v38
  v_rcp_f32 v39, v39
  v_mfma_f32_32x32x16_bf16 v[112:127], v[204:207], a[148:151], v[112:127]
  ds_read_b64_tr_b16 v[220:221], v19 offset:14336
  ds_read_b64_tr_b16 v[222:223], v19 offset:14848
  v_rcp_f32 v40, v40
  v_rcp_f32 v41, v41
  v_rcp_f32 v42, v42
  buffer_load_dwordx4 v60, s[28:31], s62 offen offset:1024 lds
  s_waitcnt vmcnt(18)
  s_barrier
  s_waitcnt lgkmcnt(4)
  v_mfma_f32_32x32x16_bf16 v[96:111], v[208:211], a[152:155], v[96:111]
  ds_read_b64_tr_b16 v[192:193], v18 offset:16384
  ds_read_b64_tr_b16 v[194:195], v18 offset:16896
  v_rcp_f32 v43, v43
  v_rcp_f32 v44, v44
  v_rcp_f32 v45, v45
  v_mfma_f32_32x32x16_bf16 v[112:127], v[212:215], a[152:155], v[112:127]
  ds_read_b64_tr_b16 v[196:197], v19 offset:16384
  ds_read_b64_tr_b16 v[198:199], v19 offset:16896
  v_mul_f32 v38, v38, v64
  v_mul_f32 v39, v39, v65
  v_mul_f32 v40, v40, v66
  v_mul_f32 v41, v41, v67
  v_mul_f32 v42, v42, v68
  v_mul_f32 v43, v43, v69
  buffer_load_dwordx4 v61, s[28:31], s62 offen offset:2048 lds
  s_waitcnt lgkmcnt(4)
  v_mfma_f32_32x32x16_bf16 v[96:111], v[216:219], a[156:159], v[96:111]
  ds_read_b64_tr_b16 v[200:201], v18 offset:18432
  ds_read_b64_tr_b16 v[202:203], v18 offset:18944
  v_mul_f32 v44, v44, v70
  v_mul_f32 v45, v45, v71
  v_cvt_pk_bf16_f32 v224, v38, v39
  v_cvt_pk_bf16_f32 v225, v40, v41
  v_cvt_pk_bf16_f32 v226, v42, v43
  v_cvt_pk_bf16_f32 v227, v44, v45
  v_mfma_f32_32x32x16_bf16 v[112:127], v[220:223], a[156:159], v[112:127]
  ds_read_b64_tr_b16 v[204:205], v19 offset:18432
  ds_read_b64_tr_b16 v[206:207], v19 offset:18944
  buffer_store_dwordx4 v[224:227], v24, s[32:35], s69 offen offset:0 sc1
  v_mul_f32 v46, v72, v72
  v_mul_f32 v47, v73, v73
  v_mul_f32 v48, v74, v74
  buffer_load_dwordx4 v62, s[28:31], s62 offen offset:3072 lds
  s_waitcnt lgkmcnt(4)
  v_mfma_f32_32x32x16_bf16 v[96:111], v[192:195], a[160:163], v[96:111]
  ds_read_b64_tr_b16 v[208:209], v18 offset:20480
  ds_read_b64_tr_b16 v[210:211], v18 offset:20992
  v_mul_f32 v49, v75, v75
  v_mul_f32 v50, v76, v76
  v_mul_f32 v51, v77, v77
  v_mul_f32 v52, v78, v78
  v_mul_f32 v53, v79, v79
  v_fmaak_f32 v46, v46, v56, 0xc0135761
  v_mfma_f32_32x32x16_bf16 v[112:127], v[196:199], a[160:163], v[112:127]
  ds_read_b64_tr_b16 v[212:213], v19 offset:20480
  ds_read_b64_tr_b16 v[214:215], v19 offset:20992
  v_fmaak_f32 v47, v47, v56, 0xc0135761
  v_fmaak_f32 v48, v48, v56, 0xc0135761
  v_fmaak_f32 v49, v49, v56, 0xc0135761
  v_fmaak_f32 v50, v50, v56, 0xc0135761
  v_fmaak_f32 v51, v51, v56, 0xc0135761
  v_fmaak_f32 v52, v52, v56, 0xc0135761
  s_waitcnt lgkmcnt(4)
  v_mfma_f32_32x32x16_bf16 v[96:111], v[200:203], a[164:167], v[96:111]
  ds_read_b64_tr_b16 v[216:217], v18 offset:22528
  ds_read_b64_tr_b16 v[218:219], v18 offset:23040
  v_fmaak_f32 v53, v53, v56, 0xc0135761
  v_mul_f32 v46, v46, v72
  v_mul_f32 v47, v47, v73
  v_mul_f32 v48, v48, v74
  v_mul_f32 v49, v49, v75
  v_mul_f32 v50, v50, v76
  s_add_u32 m0, s71, 32768
  s_bfe_u32 s62, s4, 262152
  s_mul_i32 s62, s62, 28672
  s_add_u32 s62, s62, s70
  buffer_load_dwordx4 v5, s[28:31], s62 offen offset:0 lds
  v_mfma_f32_32x32x16_bf16 v[112:127], v[204:207], a[164:167], v[112:127]
  ds_read_b64_tr_b16 v[220:221], v19 offset:22528
  ds_read_b64_tr_b16 v[222:223], v19 offset:23040
  v_mul_f32 v51, v51, v77
  v_mul_f32 v52, v52, v78
  v_mul_f32 v53, v53, v79
  v_exp_f32 v46, v46
  s_waitcnt lgkmcnt(4)
  v_mfma_f32_32x32x16_bf16 v[96:111], v[208:211], a[168:171], v[96:111]
  ds_read_b64_tr_b16 v[192:193], v18 offset:24576
  ds_read_b64_tr_b16 v[194:195], v18 offset:25088
  v_exp_f32 v47, v47
  v_exp_f32 v48, v48
  v_exp_f32 v49, v49
  buffer_load_dwordx4 v60, s[28:31], s62 offen offset:1024 lds
  v_mfma_f32_32x32x16_bf16 v[112:127], v[212:215], a[168:171], v[112:127]
  ds_read_b64_tr_b16 v[196:197], v19 offset:24576
  ds_read_b64_tr_b16 v[198:199], v19 offset:25088
  v_exp_f32 v50, v50
  v_exp_f32 v51, v51
  v_exp_f32 v52, v52
  s_waitcnt lgkmcnt(4)
  v_mfma_f32_32x32x16_bf16 v[96:111], v[216:219], a[172:175], v[96:111]
  ds_read_b64_tr_b16 v[200:201], v18 offset:26624
  ds_read_b64_tr_b16 v[202:203], v18 offset:27136
  v_exp_f32 v53, v53
  v_add_f32 v46, 1.0, v46
  v_add_f32 v47, 1.0, v47
  v_add_f32 v48, 1.0, v48
  v_add_f32 v49, 1.0, v49
  buffer_load_dwordx4 v61, s[28:31], s62 offen offset:2048 lds
  v_mfma_f32_32x32x16_bf16 v[112:127], v[220:223], a[172:175], v[112:127]
  ds_read_b64_tr_b16 v[204:205], v19 offset:26624
  ds_read_b64_tr_b16 v[206:207], v19 offset:27136
  v_add_f32 v50, 1.0, v50
  v_add_f32 v51, 1.0, v51
  v_add_f32 v52, 1.0, v52
  v_add_f32 v53, 1.0, v53
  v_rcp_f32 v46, v46
  s_waitcnt lgkmcnt(4)
  v_mfma_f32_32x32x16_bf16 v[96:111], v[192:195], a[176:179], v[96:111]
  ds_read_b64_tr_b16 v[208:209], v18 offset:28672
  ds_read_b64_tr_b16 v[210:211], v18 offset:29184
  v_rcp_f32 v47, v47
  v_rcp_f32 v48, v48
  v_rcp_f32 v49, v49
  buffer_load_dwordx4 v62, s[28:31], s62 offen offset:3072 lds
  v_mfma_f32_32x32x16_bf16 v[112:127], v[196:199], a[176:179], v[112:127]
  ds_read_b64_tr_b16 v[212:213], v19 offset:28672
  ds_read_b64_tr_b16 v[214:215], v19 offset:29184
  v_rcp_f32 v50, v50
  v_rcp_f32 v51, v51
  v_rcp_f32 v52, v52
  s_waitcnt lgkmcnt(4)
  v_mfma_f32_32x32x16_bf16 v[96:111], v[200:203], a[180:183], v[96:111]
  ds_read_b64_tr_b16 v[216:217], v18 offset:30720
  ds_read_b64_tr_b16 v[218:219], v18 offset:31232
  v_rcp_f32 v53, v53
  v_mul_f32 v46, v46, v72
  v_mul_f32 v47, v47, v73
  v_mul_f32 v48, v48, v74
  v_mfma_f32_32x32x16_bf16 v[112:127], v[204:207], a[180:183], v[112:127]
  ds_read_b64_tr_b16 v[220:221], v19 offset:30720
  ds_read_b64_tr_b16 v[222:223], v19 offset:31232
  v_mul_f32 v49, v49, v75
  v_mul_f32 v50, v50, v76
  v_mul_f32 v51, v51, v77
  v_mul_f32 v52, v52, v78
  v_mul_f32 v53, v53, v79
  v_cvt_pk_bf16_f32 v228, v46, v47
  s_add_u32 m0, s71, 36864
  s_bfe_u32 s62, s4, 262156
  s_mul_i32 s62, s62, 28672
  s_add_u32 s62, s62, s70
  buffer_load_dwordx4 v5, s[28:31], s62 offen offset:0 lds
  s_waitcnt vmcnt(18)
  s_barrier
  s_waitcnt lgkmcnt(4)
  v_mfma_f32_32x32x16_bf16 v[96:111], v[208:211], a[184:187], v[96:111]
  ds_read_b64_tr_b16 v[192:193], v18 offset:32768
  ds_read_b64_tr_b16 v[194:195], v18 offset:33280
  v_cvt_pk_bf16_f32 v229, v48, v49
  v_cvt_pk_bf16_f32 v230, v50, v51
  v_cvt_pk_bf16_f32 v231, v52, v53
  buffer_store_dwordx4 v[228:231], v24, s[32:35], s69 offen offset:1024 sc1
  v_mfma_f32_32x32x16_bf16 v[112:127], v[212:215], a[184:187], v[112:127]
  ds_read_b64_tr_b16 v[196:197], v19 offset:32768
  ds_read_b64_tr_b16 v[198:199], v19 offset:33280
  v_mul_f32 v38, v80, v80
  v_mul_f32 v39, v81, v81
  v_mul_f32 v40, v82, v82
  v_mul_f32 v41, v83, v83
  v_mul_f32 v42, v84, v84
  v_mul_f32 v43, v85, v85
  buffer_load_dwordx4 v60, s[28:31], s62 offen offset:1024 lds
  s_waitcnt lgkmcnt(4)
  v_mfma_f32_32x32x16_bf16 v[96:111], v[216:219], a[188:191], v[96:111]
  ds_read_b64_tr_b16 v[200:201], v18 offset:34816
  ds_read_b64_tr_b16 v[202:203], v18 offset:35328
  v_mul_f32 v44, v86, v86
  v_mul_f32 v45, v87, v87
  v_fmaak_f32 v38, v38, v56, 0xc0135761
  v_fmaak_f32 v39, v39, v56, 0xc0135761
  v_fmaak_f32 v40, v40, v56, 0xc0135761
  v_fmaak_f32 v41, v41, v56, 0xc0135761
  v_mfma_f32_32x32x16_bf16 v[112:127], v[220:223], a[188:191], v[112:127]
  ds_read_b64_tr_b16 v[204:205], v19 offset:34816
  ds_read_b64_tr_b16 v[206:207], v19 offset:35328
  v_fmaak_f32 v42, v42, v56, 0xc0135761
  v_fmaak_f32 v43, v43, v56, 0xc0135761
  v_fmaak_f32 v44, v44, v56, 0xc0135761
  v_fmaak_f32 v45, v45, v56, 0xc0135761
  v_mul_f32 v38, v38, v80
  v_mul_f32 v39, v39, v81
  buffer_load_dwordx4 v61, s[28:31], s62 offen offset:2048 lds
  s_waitcnt lgkmcnt(4)
  v_mfma_f32_32x32x16_bf16 v[96:111], v[192:195], a[192:195], v[96:111]
  ds_read_b64_tr_b16 v[208:209], v18 offset:36864
  ds_read_b64_tr_b16 v[210:211], v18 offset:37376
  v_mul_f32 v40, v40, v82
  v_mul_f32 v41, v41, v83
  v_mul_f32 v42, v42, v84
  v_mul_f32 v43, v43, v85
  v_mul_f32 v44, v44, v86
  v_mul_f32 v45, v45, v87
  v_mfma_f32_32x32x16_bf16 v[112:127], v[196:199], a[192:195], v[112:127]
  ds_read_b64_tr_b16 v[212:213], v19 offset:36864
  ds_read_b64_tr_b16 v[214:215], v19 offset:37376
  v_exp_f32 v38, v38
  v_exp_f32 v39, v39
  v_exp_f32 v40, v40
  buffer_load_dwordx4 v62, s[28:31], s62 offen offset:3072 lds
  s_waitcnt lgkmcnt(4)
  v_mfma_f32_32x32x16_bf16 v[96:111], v[200:203], a[196:199], v[96:111]
  ds_read_b64_tr_b16 v[216:217], v18 offset:38912
  ds_read_b64_tr_b16 v[218:219], v18 offset:39424
  v_exp_f32 v41, v41
  v_exp_f32 v42, v42
  v_exp_f32 v43, v43
  v_mfma_f32_32x32x16_bf16 v[112:127], v[204:207], a[196:199], v[112:127]
  ds_read_b64_tr_b16 v[220:221], v19 offset:38912
  ds_read_b64_tr_b16 v[222:223], v19 offset:39424
  v_exp_f32 v44, v44
  v_exp_f32 v45, v45
  v_add_f32 v38, 1.0, v38
  s_waitcnt lgkmcnt(4)
  v_mfma_f32_32x32x16_bf16 v[96:111], v[208:211], a[200:203], v[96:111]
  ds_read_b64_tr_b16 v[192:193], v18 offset:40960
  ds_read_b64_tr_b16 v[194:195], v18 offset:41472
  v_add_f32 v39, 1.0, v39
  v_add_f32 v40, 1.0, v40
  v_add_f32 v41, 1.0, v41
  v_add_f32 v42, 1.0, v42
  v_add_f32 v43, 1.0, v43
  v_add_f32 v44, 1.0, v44
  s_add_u32 m0, s71, 65536
  s_bfe_u32 s62, s4, 262160
  s_mul_i32 s62, s62, 28672
  s_add_u32 s62, s62, s70
  buffer_load_dwordx4 v5, s[28:31], s62 offen offset:0 lds
  v_mfma_f32_32x32x16_bf16 v[112:127], v[212:215], a[200:203], v[112:127]
  ds_read_b64_tr_b16 v[196:197], v19 offset:40960
  ds_read_b64_tr_b16 v[198:199], v19 offset:41472
  v_add_f32 v45, 1.0, v45
  v_rcp_f32 v38, v38
  v_rcp_f32 v39, v39
  s_waitcnt lgkmcnt(4)
  v_mfma_f32_32x32x16_bf16 v[96:111], v[216:219], a[204:207], v[96:111]
  ds_read_b64_tr_b16 v[200:201], v18 offset:43008
  ds_read_b64_tr_b16 v[202:203], v18 offset:43520
  v_rcp_f32 v40, v40
  v_rcp_f32 v41, v41
  v_rcp_f32 v42, v42
  buffer_load_dwordx4 v60, s[28:31], s62 offen offset:1024 lds
  v_mfma_f32_32x32x16_bf16 v[112:127], v[220:223], a[204:207], v[112:127]
  ds_read_b64_tr_b16 v[204:205], v19 offset:43008
  ds_read_b64_tr_b16 v[206:207], v19 offset:43520
  v_rcp_f32 v43, v43
  v_rcp_f32 v44, v44
  v_rcp_f32 v45, v45
  s_waitcnt lgkmcnt(4)
  v_mfma_f32_32x32x16_bf16 v[96:111], v[192:195], a[208:211], v[96:111]
  ds_read_b64_tr_b16 v[208:209], v18 offset:45056
  ds_read_b64_tr_b16 v[210:211], v18 offset:45568
  v_mul_f32 v38, v38, v80
  v_mul_f32 v39, v39, v81
  v_mul_f32 v40, v40, v82
  v_mul_f32 v41, v41, v83
  v_mul_f32 v42, v42, v84
  v_mul_f32 v43, v43, v85
  buffer_load_dwordx4 v61, s[28:31], s62 offen offset:2048 lds
  v_mfma_f32_32x32x16_bf16 v[112:127], v[196:199], a[208:211], v[112:127]
  ds_read_b64_tr_b16 v[212:213], v19 offset:45056
  ds_read_b64_tr_b16 v[214:215], v19 offset:45568
  v_mul_f32 v44, v44, v86
  v_mul_f32 v45, v45, v87
  v_cvt_pk_bf16_f32 v232, v38, v39
  v_cvt_pk_bf16_f32 v233, v40, v41
  v_cvt_pk_bf16_f32 v234, v42, v43
  v_cvt_pk_bf16_f32 v235, v44, v45
  s_waitcnt lgkmcnt(4)
  v_mfma_f32_32x32x16_bf16 v[96:111], v[200:203], a[212:215], v[96:111]
  ds_read_b64_tr_b16 v[216:217], v18 offset:47104
  ds_read_b64_tr_b16 v[218:219], v18 offset:47616
  buffer_store_dwordx4 v[232:235], v24, s[32:35], s69 offen offset:2048 sc1
  v_mul_f32 v46, v88, v88
  v_mul_f32 v47, v89, v89
  v_mul_f32 v48, v90, v90
  buffer_load_dwordx4 v62, s[28:31], s62 offen offset:3072 lds
  v_mfma_f32_32x32x16_bf16 v[112:127], v[204:207], a[212:215], v[112:127]
  ds_read_b64_tr_b16 v[220:221], v19 offset:47104
  ds_read_b64_tr_b16 v[222:223], v19 offset:47616
  v_mul_f32 v49, v91, v91
  v_mul_f32 v50, v92, v92
  v_mul_f32 v51, v93, v93
  v_mul_f32 v52, v94, v94
  v_mul_f32 v53, v95, v95
  v_fmaak_f32 v46, v46, v56, 0xc0135761
  s_waitcnt lgkmcnt(4)
  v_mfma_f32_32x32x16_bf16 v[96:111], v[208:211], a[216:219], v[96:111]
  ds_read_b64_tr_b16 v[192:193], v18 offset:49152
  ds_read_b64_tr_b16 v[194:195], v18 offset:49664
  v_fmaak_f32 v47, v47, v56, 0xc0135761
  v_fmaak_f32 v48, v48, v56, 0xc0135761
  v_fmaak_f32 v49, v49, v56, 0xc0135761
  v_fmaak_f32 v50, v50, v56, 0xc0135761
  v_fmaak_f32 v51, v51, v56, 0xc0135761
  v_fmaak_f32 v52, v52, v56, 0xc0135761
  v_mfma_f32_32x32x16_bf16 v[112:127], v[212:215], a[216:219], v[112:127]
  ds_read_b64_tr_b16 v[196:197], v19 offset:49152
  ds_read_b64_tr_b16 v[198:199], v19 offset:49664
  v_fmaak_f32 v53, v53, v56, 0xc0135761
  v_mul_f32 v46, v46, v88
  v_mul_f32 v47, v47, v89
  v_mul_f32 v48, v48, v90
  v_mul_f32 v49, v49, v91
  v_mul_f32 v50, v50, v92
  s_add_u32 m0, s71, 69632
  s_bfe_u32 s62, s4, 262164
  s_mul_i32 s62, s62, 28672
  s_add_u32 s62, s62, s70
  buffer_load_dwordx4 v5, s[28:31], s62 offen offset:0 lds
  s_waitcnt lgkmcnt(4)
  v_mfma_f32_32x32x16_bf16 v[96:111], v[216:219], a[220:223], v[96:111]
  ds_read_b64_tr_b16 v[200:201], v18 offset:51200
  ds_read_b64_tr_b16 v[202:203], v18 offset:51712
  v_mul_f32 v51, v51, v93
  v_mul_f32 v52, v52, v94
  v_mul_f32 v53, v53, v95
  v_exp_f32 v46, v46
  v_mfma_f32_32x32x16_bf16 v[112:127], v[220:223], a[220:223], v[112:127]
  ds_read_b64_tr_b16 v[204:205], v19 offset:51200
  ds_read_b64_tr_b16 v[206:207], v19 offset:51712
  v_exp_f32 v47, v47
  v_exp_f32 v48, v48
  v_exp_f32 v49, v49
  buffer_load_dwordx4 v60, s[28:31], s62 offen offset:1024 lds
  s_waitcnt lgkmcnt(4)
  v_mfma_f32_32x32x16_bf16 v[96:111], v[192:195], a[224:227], v[96:111]
  ds_read_b64_tr_b16 v[208:209], v18 offset:53248
  ds_read_b64_tr_b16 v[210:211], v18 offset:53760
  v_exp_f32 v50, v50
  v_exp_f32 v51, v51
  v_exp_f32 v52, v52
  v_mfma_f32_32x32x16_bf16 v[112:127], v[196:199], a[224:227], v[112:127]
  ds_read_b64_tr_b16 v[212:213], v19 offset:53248
  ds_read_b64_tr_b16 v[214:215], v19 offset:53760
  v_exp_f32 v53, v53
  v_add_f32 v46, 1.0, v46
  v_add_f32 v47, 1.0, v47
  v_add_f32 v48, 1.0, v48
  v_add_f32 v49, 1.0, v49
  buffer_load_dwordx4 v61, s[28:31], s62 offen offset:2048 lds
  s_waitcnt lgkmcnt(4)
  v_mfma_f32_32x32x16_bf16 v[96:111], v[200:203], a[228:231], v[96:111]
  ds_read_b64_tr_b16 v[216:217], v18 offset:55296
  ds_read_b64_tr_b16 v[218:219], v18 offset:55808
  v_add_f32 v50, 1.0, v50
  v_add_f32 v51, 1.0, v51
  v_add_f32 v52, 1.0, v52
  v_add_f32 v53, 1.0, v53
  v_rcp_f32 v46, v46
  v_mfma_f32_32x32x16_bf16 v[112:127], v[204:207], a[228:231], v[112:127]
  ds_read_b64_tr_b16 v[220:221], v19 offset:55296
  ds_read_b64_tr_b16 v[222:223], v19 offset:55808
  v_rcp_f32 v47, v47
  v_rcp_f32 v48, v48
  v_rcp_f32 v49, v49
  buffer_load_dwordx4 v62, s[28:31], s62 offen offset:3072 lds
  s_waitcnt lgkmcnt(4)
  v_mfma_f32_32x32x16_bf16 v[96:111], v[208:211], a[232:235], v[96:111]
  v_rcp_f32 v50, v50
  v_rcp_f32 v51, v51
  v_rcp_f32 v52, v52
  v_mfma_f32_32x32x16_bf16 v[112:127], v[212:215], a[232:235], v[112:127]
  v_rcp_f32 v53, v53
  v_mul_f32 v46, v46, v88
  v_mul_f32 v47, v47, v89
  v_mul_f32 v48, v48, v90
  s_waitcnt lgkmcnt(0)
  v_mfma_f32_32x32x16_bf16 v[96:111], v[216:219], a[236:239], v[96:111]
  v_mul_f32 v49, v49, v91
  v_mul_f32 v50, v50, v92
  v_mul_f32 v51, v51, v93
  v_mul_f32 v52, v52, v94
  v_mul_f32 v53, v53, v95
  v_cvt_pk_bf16_f32 v236, v46, v47
  v_mfma_f32_32x32x16_bf16 v[112:127], v[220:223], a[236:239], v[112:127]
  v_cvt_pk_bf16_f32 v237, v48, v49
  v_cvt_pk_bf16_f32 v238, v50, v51
  v_cvt_pk_bf16_f32 v239, v52, v53
  buffer_store_dwordx4 v[236:239], v24, s[32:35], s69 offen offset:3072 sc1
  s_lshl_b32 s60, s59, 1
  s_mul_i32 s60, s60, 112
  s_mul_i32 s61, s52, 28
  s_add_u32 s60, s60, s61
  s_lshl_b32 s11, s60, 10
  v_add_u32 v63, 131072, v20
  v_add_u32 v37, 131072, v21
  s_barrier
  s_add_u32 m0, s71, 98304
  s_bfe_u32 s62, s4, 262168
  s_mul_i32 s62, s62, 28672
  s_add_u32 s62, s62, s70
  buffer_load_dwordx4 v5, s[28:31], s62 offen offset:0 lds
  buffer_load_dwordx4 v60, s[28:31], s62 offen offset:1024 lds
  buffer_load_dwordx4 v61, s[28:31], s62 offen offset:2048 lds
  buffer_load_dwordx4 v62, s[28:31], s62 offen offset:3072 lds
  s_add_u32 m0, s71, 102400
  s_bfe_u32 s62, s4, 262172
  s_mul_i32 s62, s62, 28672
  s_add_u32 s62, s62, s70
  buffer_load_dwordx4 v5, s[28:31], s62 offen offset:0 lds
  buffer_load_dwordx4 v60, s[28:31], s62 offen offset:1024 lds
  buffer_load_dwordx4 v61, s[28:31], s62 offen offset:2048 lds
  buffer_load_dwordx4 v62, s[28:31], s62 offen offset:3072 lds
  v_pk_mul_f32 v[38:39], v[96:97], v[96:97]
  v_pk_mul_f32 v[40:41], v[98:99], v[98:99]
  v_pk_mul_f32 v[42:43], v[100:101], v[100:101]
  v_pk_mul_f32 v[44:45], v[102:103], v[102:103]
  v_pk_fma_f32 v[38:39], v[38:39], v[56:57], v[54:55]
  s_add_u32 m0, s71, 131072
  s_bfe_u32 s62, s5, 262144
  s_mul_i32 s62, s62, 28672
  s_add_u32 s62, s62, s70
  buffer_load_dwordx4 v5, s[28:31], s62 offen offset:0 lds
  v_pk_fma_f32 v[40:41], v[40:41], v[56:57], v[54:55]
  v_pk_fma_f32 v[42:43], v[42:43], v[56:57], v[54:55]
  v_pk_fma_f32 v[44:45], v[44:45], v[56:57], v[54:55]
  v_pk_mul_f32 v[38:39], v[38:39], v[96:97]
  v_pk_mul_f32 v[40:41], v[40:41], v[98:99]
  v_pk_mul_f32 v[42:43], v[42:43], v[100:101]
  v_pk_mul_f32 v[44:45], v[44:45], v[102:103]
  v_exp_f32 v38, v38
  v_exp_f32 v39, v39
  v_exp_f32 v40, v40
  v_exp_f32 v41, v41
  v_exp_f32 v42, v42
  v_exp_f32 v43, v43
  v_exp_f32 v44, v44
  v_exp_f32 v45, v45
  v_pk_add_f32 v[38:39], v[38:39], v[58:59]
  v_pk_add_f32 v[40:41], v[40:41], v[58:59]
  v_pk_add_f32 v[42:43], v[42:43], v[58:59]
  v_pk_add_f32 v[44:45], v[44:45], v[58:59]
  buffer_load_dwordx4 v60, s[28:31], s62 offen offset:1024 lds
  v_rcp_f32 v38, v38
  v_rcp_f32 v39, v39
  v_rcp_f32 v40, v40
  v_rcp_f32 v41, v41
  v_rcp_f32 v42, v42
  v_rcp_f32 v43, v43
  v_rcp_f32 v44, v44
  v_rcp_f32 v45, v45
  v_pk_mul_f32 v[38:39], v[38:39], v[96:97]
  v_pk_mul_f32 v[40:41], v[40:41], v[98:99]
  v_pk_mul_f32 v[42:43], v[42:43], v[100:101]
  v_pk_mul_f32 v[44:45], v[44:45], v[102:103]
  v_cvt_pk_bf16_f32 v240, v38, v39
  v_cvt_pk_bf16_f32 v241, v40, v41
  v_cvt_pk_bf16_f32 v242, v42, v43
  v_cvt_pk_bf16_f32 v243, v44, v45
  s_add_u32 s60, s69, 4096
  buffer_store_dwordx4 v[240:243], v24, s[32:35], s60 offen offset:0 sc1
  v_pk_mul_f32 v[46:47], v[104:105], v[104:105]
  v_pk_mul_f32 v[48:49], v[106:107], v[106:107]
  v_pk_mul_f32 v[50:51], v[108:109], v[108:109]
  buffer_load_dwordx4 v61, s[28:31], s62 offen offset:2048 lds
  v_pk_mul_f32 v[52:53], v[110:111], v[110:111]
  v_pk_fma_f32 v[46:47], v[46:47], v[56:57], v[54:55]
  v_pk_fma_f32 v[48:49], v[48:49], v[56:57], v[54:55]
  v_pk_fma_f32 v[50:51], v[50:51], v[56:57], v[54:55]
  v_pk_fma_f32 v[52:53], v[52:53], v[56:57], v[54:55]
  v_pk_mul_f32 v[46:47], v[46:47], v[104:105]
  v_pk_mul_f32 v[48:49], v[48:49], v[106:107]
  v_pk_mul_f32 v[50:51], v[50:51], v[108:109]
  v_pk_mul_f32 v[52:53], v[52:53], v[110:111]
  v_exp_f32 v46, v46
  v_exp_f32 v47, v47
  v_exp_f32 v48, v48
  v_exp_f32 v49, v49
  v_exp_f32 v50, v50
  v_exp_f32 v51, v51
  v_exp_f32 v52, v52
  v_exp_f32 v53, v53
  v_pk_add_f32 v[46:47], v[46:47], v[58:59]
  v_pk_add_f32 v[48:49], v[48:49], v[58:59]
  buffer_load_dwordx4 v62, s[28:31], s62 offen offset:3072 lds
  v_pk_add_f32 v[50:51], v[50:51], v[58:59]
  v_pk_add_f32 v[52:53], v[52:53], v[58:59]
  v_rcp_f32 v46, v46
  v_rcp_f32 v47, v47
  v_rcp_f32 v48, v48
  v_rcp_f32 v49, v49
  v_rcp_f32 v50, v50
  v_rcp_f32 v51, v51
  v_rcp_f32 v52, v52
  v_rcp_f32 v53, v53
  v_pk_mul_f32 v[46:47], v[46:47], v[104:105]
  v_pk_mul_f32 v[48:49], v[48:49], v[106:107]
  v_pk_mul_f32 v[50:51], v[50:51], v[108:109]
  v_pk_mul_f32 v[52:53], v[52:53], v[110:111]
  v_cvt_pk_bf16_f32 v244, v46, v47
  v_cvt_pk_bf16_f32 v245, v48, v49
  v_cvt_pk_bf16_f32 v246, v50, v51
  v_cvt_pk_bf16_f32 v247, v52, v53
  s_add_u32 s60, s69, 4096
  buffer_store_dwordx4 v[244:247], v24, s[32:35], s60 offen offset:1024 sc1
  v_pk_mul_f32 v[38:39], v[112:113], v[112:113]
  s_add_u32 m0, s71, 135168
  s_bfe_u32 s62, s5, 262148
  s_mul_i32 s62, s62, 28672
  s_add_u32 s62, s62, s70
  buffer_load_dwordx4 v5, s[28:31], s62 offen offset:0 lds
  v_pk_mul_f32 v[40:41], v[114:115], v[114:115]
  v_pk_mul_f32 v[42:43], v[116:117], v[116:117]
  v_pk_mul_f32 v[44:45], v[118:119], v[118:119]
  v_pk_fma_f32 v[38:39], v[38:39], v[56:57], v[54:55]
  v_pk_fma_f32 v[40:41], v[40:41], v[56:57], v[54:55]
  v_pk_fma_f32 v[42:43], v[42:43], v[56:57], v[54:55]
  v_pk_fma_f32 v[44:45], v[44:45], v[56:57], v[54:55]
  v_pk_mul_f32 v[38:39], v[38:39], v[112:113]
  v_pk_mul_f32 v[40:41], v[40:41], v[114:115]
  v_pk_mul_f32 v[42:43], v[42:43], v[116:117]
  v_pk_mul_f32 v[44:45], v[44:45], v[118:119]
  v_exp_f32 v38, v38
  v_exp_f32 v39, v39
  v_exp_f32 v40, v40
  v_exp_f32 v41, v41
  v_exp_f32 v42, v42
  v_exp_f32 v43, v43
  v_exp_f32 v44, v44
  s_waitcnt vmcnt(15)
  s_mov_b32 s63, 0
L_nonp0:
  v_cmp_ne_u32 vcc, 0, v30
  s_cbranch_vccnz L_nonp_ok0
  s_lshl_b32 s60, s3, 3
  s_and_b32 s61, s52, 1
  s_lshl_b32 s61, s61, 2
  s_add_u32 s60, s60, s61
  buffer_load_dword v30, v35, s[48:51], s60 offen sc1
  s_waitcnt vmcnt(0)
  s_add_u32 s63, s63, 1
  s_cmp_lt_u32 s63, 0x40000
  s_cbranch_scc1 L_nonp0
L_nonp_ok0:
  s_mov_b64 exec, 1
  buffer_store_dword v30, v27, s[32:35], 0 offen sc1
  s_mov_b64 exec, -1
  s_mov_b32 s63, 0
L_nonc:
  v_min_u32 v34, v32, v33
  v_cmp_ne_u32 vcc, 0, v34
  s_cbranch_vccnz L_nonc_ok
  s_lshl_b32 s60, s59, 3
  buffer_load_dwordx2 v[32:33], v35, s[48:51], s60 offen sc1
  s_waitcnt vmcnt(0)
  s_add_u32 s63, s63, 1
  s_cmp_lt_u32 s63, 0x40000
  s_cbranch_scc1 L_nonc
L_nonc_ok:
  v_bfe_u32 v34, v1, 3, 1
  v_cmp_eq_u32 vcc, 1, v34
  s_nop 1
  v_cndmask_b32 v31, v32, v33, vcc
  v_exp_f32 v45, v45
  buffer_load_dwordx4 v60, s[28:31], s62 offen offset:1024 lds
  v_pk_add_f32 v[38:39], v[38:39], v[58:59]
  v_pk_add_f32 v[40:41], v[40:41], v[58:59]
  v_pk_add_f32 v[42:43], v[42:43], v[58:59]
  v_pk_add_f32 v[44:45], v[44:45], v[58:59]
  v_rcp_f32 v38, v38
  v_rcp_f32 v39, v39
  v_rcp_f32 v40, v40
  v_rcp_f32 v41, v41
  v_rcp_f32 v42, v42
  v_rcp_f32 v43, v43
  v_rcp_f32 v44, v44
  v_rcp_f32 v45, v45
  v_pk_mul_f32 v[38:39], v[38:39], v[112:113]
  v_pk_mul_f32 v[40:41], v[40:41], v[114:115]
  v_pk_mul_f32 v[42:43], v[42:43], v[116:117]
  v_pk_mul_f32 v[44:45], v[44:45], v[118:119]
  v_cvt_pk_bf16_f32 v248, v38, v39
  v_cvt_pk_bf16_f32 v249, v40, v41
  v_cvt_pk_bf16_f32 v250, v42, v43
  v_cvt_pk_bf16_f32 v251, v44, v45
  buffer_load_dwordx4 v61, s[28:31], s62 offen offset:2048 lds
  s_add_u32 s60, s69, 4096
  buffer_store_dwordx4 v[248:251], v24, s[32:35], s60 offen offset:2048 sc1
  v_pk_mul_f32 v[46:47], v[120:121], v[120:121]
  v_pk_mul_f32 v[48:49], v[122:123], v[122:123]
  v_pk_mul_f32 v[50:51], v[124:125], v[124:125]
  v_pk_mul_f32 v[52:53], v[126:127], v[126:127]
  v_pk_fma_f32 v[46:47], v[46:47], v[56:57], v[54:55]
  v_pk_fma_f32 v[48:49], v[48:49], v[56:57], v[54:55]
  v_pk_fma_f32 v[50:51], v[50:51], v[56:57], v[54:55]
  v_pk_fma_f32 v[52:53], v[52:53], v[56:57], v[54:55]
  v_pk_mul_f32 v[46:47], v[46:47], v[120:121]
  v_pk_mul_f32 v[48:49], v[48:49], v[122:123]
  v_pk_mul_f32 v[50:51], v[50:51], v[124:125]
  v_pk_mul_f32 v[52:53], v[52:53], v[126:127]
  v_exp_f32 v46, v46
  v_exp_f32 v47, v47
  v_exp_f32 v48, v48
  v_exp_f32 v49, v49
  v_exp_f32 v50, v50
  v_exp_f32 v51, v51
  buffer_load_dwordx4 v62, s[28:31], s62 offen offset:3072 lds
  v_exp_f32 v52, v52
  v_exp_f32 v53, v53
  v_pk_add_f32 v[46:47], v[46:47], v[58:59]
  v_pk_add_f32 v[48:49], v[48:49], v[58:59]
  v_pk_add_f32 v[50:51], v[50:51], v[58:59]
  v_pk_add_f32 v[52:53], v[52:53], v[58:59]
  v_rcp_f32 v46, v46
  v_rcp_f32 v47, v47
  v_rcp_f32 v48, v48
  v_rcp_f32 v49, v49
  v_rcp_f32 v50, v50
  v_rcp_f32 v51, v51
  v_rcp_f32 v52, v52
  v_rcp_f32 v53, v53
  v_pk_mul_f32 v[46:47], v[46:47], v[120:121]
  v_pk_mul_f32 v[48:49], v[48:49], v[122:123]
  v_pk_mul_f32 v[50:51], v[50:51], v[124:125]
  v_pk_mul_f32 v[52:53], v[52:53], v[126:127]
  v_cvt_pk_bf16_f32 v252, v46, v47
  v_cvt_pk_bf16_f32 v253, v48, v49
  v_cvt_pk_bf16_f32 v254, v50, v51
  v_cvt_pk_bf16_f32 v255, v52, v53
  s_add_u32 s60, s69, 4096
  buffer_store_dwordx4 v[252:255], v24, s[32:35], s60 offen offset:3072 sc1
  ds_read_b64_tr_b16 a[0:1], v20 offset:0
  ds_read_b64_tr_b16 a[2:3], v20 offset:1024
  ds_read_b64_tr_b16 a[4:5], v21 offset:0
  ds_read_b64_tr_b16 a[6:7], v21 offset:1024
  ds_read_b64_tr_b16 a[8:9], v20 offset:2048
  ds_read_b64_tr_b16 a[10:11], v20 offset:3072
  ds_read_b64_tr_b16 a[12:13], v21 offset:2048
  ds_read_b64_tr_b16 a[14:15], v21 offset:3072
  ds_read_b64_tr_b16 a[16:17], v20 offset:4096
  ds_read_b64_tr_b16 a[18:19], v20 offset:5120
  ds_read_b64_tr_b16 a[20:21], v21 offset:4096
  ds_read_b64_tr_b16 a[22:23], v21 offset:5120
  ds_read_b64_tr_b16 a[24:25], v20 offset:6144
  ds_read_b64_tr_b16 a[26:27], v20 offset:7168
  ds_read_b64_tr_b16 a[28:29], v21 offset:6144
  ds_read_b64_tr_b16 a[30:31], v21 offset:7168
  ds_read_b64_tr_b16 a[32:33], v20 offset:32768
  ds_read_b64_tr_b16 a[34:35], v20 offset:33792
  ds_read_b64_tr_b16 a[36:37], v21 offset:32768
  ds_read_b64_tr_b16 a[38:39], v21 offset:33792
  ds_read_b64_tr_b16 a[40:41], v20 offset:34816
  ds_read_b64_tr_b16 a[42:43], v20 offset:35840
  ds_read_b64_tr_b16 a[44:45], v21 offset:34816
  ds_read_b64_tr_b16 a[46:47], v21 offset:35840
  ds_read_b64_tr_b16 a[48:49], v20 offset:36864
  ds_read_b64_tr_b16 a[50:51], v20 offset:37888
  ds_read_b64_tr_b16 a[52:53], v21 offset:36864
  ds_read_b64_tr_b16 a[54:55], v21 offset:37888
  ds_read_b64_tr_b16 a[56:57], v20 offset:38912
  ds_read_b64_tr_b16 a[58:59], v20 offset:39936
  ds_read_b64_tr_b16 a[60:61], v21 offset:38912
  ds_read_b64_tr_b16 a[62:63], v21 offset:39936
  s_waitcnt lgkmcnt(15)
  s_waitcnt vmcnt(0)
  s_mov_b32 s63, 0
L_nonp1:
  v_cmp_ne_u32 vcc, 0, v30
  s_cbranch_vccnz L_nonp_ok1
  s_lshl_b32 s60, s3, 3
  s_and_b32 s61, s52, 1
  s_lshl_b32 s61, s61, 2
  s_add_u32 s60, s60, s61
  buffer_load_dword v30, v35, s[48:51], s60 offen sc1
  s_waitcnt vmcnt(0)
  s_add_u32 s63, s63, 1
  s_cmp_lt_u32 s63, 0x40000
  s_cbranch_scc1 L_nonp1
L_nonp_ok1:
  s_mov_b64 exec, 1
  buffer_store_dword v30, v28, s[32:35], 0 offen sc1
  s_mov_b64 exec, -1
  s_add_u32 m0, s71, 0
  s_bfe_u32 s62, s5, 262152
  s_mul_i32 s62, s62, 28672
  s_add_u32 s62, s62, s70
  buffer_load_dwordx4 v5, s[28:31], s62 offen offset:0 lds
  buffer_load_dwordx4 v60, s[28:31], s62 offen offset:1024 lds
  buffer_load_dwordx4 v61, s[28:31], s62 offen offset:2048 lds
  buffer_load_dwordx4 v62, s[28:31], s62 offen offset:3072 lds
  s_add_u32 m0, s71, 4096
  s_bfe_u32 s62, s5, 262156
  s_mul_i32 s62, s62, 28672
  s_add_u32 s62, s62, s70
  buffer_load_dwordx4 v5, s[28:31], s62 offen offset:0 lds
  buffer_load_dwordx4 v60, s[28:31], s62 offen offset:1024 lds
  buffer_load_dwordx4 v61, s[28:31], s62 offen offset:2048 lds
  buffer_load_dwordx4 v62, s[28:31], s62 offen offset:3072 lds
  s_waitcnt lgkmcnt(0)
  s_add_u32 m0, s71, 32768
  s_bfe_u32 s62, s5, 262160
  s_mul_i32 s62, s62, 28672
  s_add_u32 s62, s62, s70
  buffer_load_dwordx4 v5, s[28:31], s62 offen offset:0 lds
  buffer_load_dwordx4 v60, s[28:31], s62 offen offset:1024 lds
  buffer_load_dwordx4 v61, s[28:31], s62 offen offset:2048 lds
  buffer_load_dwordx4 v62, s[28:31], s62 offen offset:3072 lds
  s_add_u32 m0, s71, 36864
  s_bfe_u32 s62, s5, 262164
  s_mul_i32 s62, s62, 28672
  s_add_u32 s62, s62, s70
  buffer_load_dwordx4 v5, s[28:31], s62 offen offset:0 lds
  buffer_load_dwordx4 v60, s[28:31], s62 offen offset:1024 lds
  buffer_load_dwordx4 v61, s[28:31], s62 offen offset:2048 lds
  buffer_load_dwordx4 v62, s[28:31], s62 offen offset:3072 lds
  s_mov_b64 exec, 0xffff
  buffer_load_dword v36, v29, s[32:35], 0 offen sc1
  s_mov_b64 exec, -1
  v_accvgpr_read_b32 v46, a240
  v_accvgpr_read_b32 v47, a241
  v_accvgpr_read_b32 v48, a242
  v_accvgpr_read_b32 v49, a243
  v_accvgpr_read_b32 v50, a244
  v_accvgpr_read_b32 v51, a245
  v_accvgpr_read_b32 v52, a246
  v_accvgpr_read_b32 v53, a247
  ds_read_b64_tr_b16 a[64:65], v22 offset:0
  ds_read_b64_tr_b16 a[66:67], v22 offset:1024
  ds_read_b64_tr_b16 a[68:69], v23 offset:0
  ds_read_b64_tr_b16 a[70:71], v23 offset:1024
  ds_read_b64_tr_b16 a[72:73], v22 offset:2048
  ds_read_b64_tr_b16 a[74:75], v22 offset:3072
  ds_read_b64_tr_b16 a[76:77], v23 offset:2048
  ds_read_b64_tr_b16 a[78:79], v23 offset:3072
  ds_read_b64_tr_b16 a[80:81], v22 offset:4096
  ds_read_b64_tr_b16 a[82:83], v22 offset:5120
  ds_read_b64_tr_b16 a[84:85], v23 offset:4096
  ds_read_b64_tr_b16 a[86:87], v23 offset:5120
  ds_read_b64_tr_b16 a[88:89], v22 offset:6144
  ds_read_b64_tr_b16 a[90:91], v22 offset:7168
  ds_read_b64_tr_b16 a[92:93], v23 offset:6144
  ds_read_b64_tr_b16 a[94:95], v23 offset:7168
  s_waitcnt vmcnt(0)
  s_mov_b32 s63, 0
L_pollA:
  v_cmp_ne_u32 vcc, v36, v31
  s_nop 0
  s_and_b32 s60, vcc_lo, s72
  s_and_b32 s60, s60, 0xffff
  s_cbranch_scc0 L_pollA_go
  s_mov_b64 exec, 0xffff
  buffer_load_dword v36, v29, s[32:35], 0 offen sc1
  s_mov_b64 exec, -1
  s_waitcnt vmcnt(0)
  s_add_u32 s63, s63, 1
  s_cmp_lt_u32 s63, 0x40000
  s_cbranch_scc1 L_pollA
L_pollA_go:
  s_mov_b64 exec, 0xffff
  buffer_load_dword v36, v29, s[32:35], 0 offen sc1
  s_mov_b64 exec, -1
  s_bfe_u32 s6, s4, 262144
  s_lshl_b32 s6, s6, 11
  s_add_u32 s6, s6, s11
  s_bfe_u32 s7, s4, 262148
  s_lshl_b32 s7, s7, 11
  s_add_u32 s7, s7, s11
  buffer_load_dwordx4 v[128:131], v25, s[32:35], s6 offen offset:0 sc1
  buffer_load_dwordx4 v[132:135], v26, s[32:35], s6 offen offset:0 sc1
  buffer_load_dwordx4 v[136:139], v25, s[32:35], s6 offen offset:1024 sc1
  buffer_load_dwordx4 v[140:143], v26, s[32:35], s6 offen offset:1024 sc1
  buffer_load_dwordx4 v[144:147], v25, s[32:35], s7 offen offset:0 sc1
  buffer_load_dwordx4 v[148:151], v26, s[32:35], s7 offen offset:0 sc1
  buffer_load_dwordx4 v[152:155], v25, s[32:35], s7 offen offset:1024 sc1
  buffer_load_dwordx4 v[156:159], v26, s[32:35], s7 offen offset:1024 sc1
  s_bfe_u32 s6, s4, 262152
  s_lshl_b32 s6, s6, 11
  s_add_u32 s6, s6, s11
  s_bfe_u32 s7, s4, 262156
  s_lshl_b32 s7, s7, 11
  s_add_u32 s7, s7, s11
  buffer_load_dwordx4 v[160:163], v25, s[32:35], s6 offen offset:0 sc1
  buffer_load_dwordx4 v[164:167], v26, s[32:35], s6 offen offset:0 sc1
  ds_read_b64_tr_b16 a[96:97], v22 offset:32768
  ds_read_b64_tr_b16 a[98:99], v22 offset:33792
  ds_read_b64_tr_b16 a[100:101], v23 offset:32768
  ds_read_b64_tr_b16 a[102:103], v23 offset:33792
  ds_read_b64_tr_b16 a[104:105], v22 offset:34816
  ds_read_b64_tr_b16 a[106:107], v22 offset:35840
  ds_read_b64_tr_b16 a[108:109], v23 offset:34816
  ds_read_b64_tr_b16 a[110:111], v23 offset:35840
  ds_read_b64_tr_b16 a[112:113], v22 offset:36864
  ds_read_b64_tr_b16 a[114:115], v22 offset:37888
  ds_read_b64_tr_b16 a[116:117], v23 offset:36864
  ds_read_b64_tr_b16 a[118:119], v23 offset:37888
  ds_read_b64_tr_b16 a[120:121], v22 offset:38912
  ds_read_b64_tr_b16 a[122:123], v22 offset:39936
  ds_read_b64_tr_b16 a[124:125], v23 offset:38912
  ds_read_b64_tr_b16 a[126:127], v23 offset:39936
  v_add_u32 v38, s71, v24
  s_xor_b32 s60, s52, 1
  s_lshl_b32 s60, s60, 13
  s_add_u32 s60, s60, 0
  v_add_u32 v39, s60, v24
  s_xor_b32 s60, s52, 2
  s_lshl_b32 s60, s60, 13
  s_add_u32 s60, s60, 4096
  v_add_u32 v40, s60, v24
  s_xor_b32 s60, s52, 3
  s_lshl_b32 s60, s60, 13
  s_add_u32 s60, s60, 32768
  v_add_u32 v41, s60, v24
  s_waitcnt vmcnt(8)
  v_mfma_f32_32x32x16_bf16 v[64:79], a[0:3], v[128:131], 0
  buffer_load_dwordx4 v[168:171], v25, s[32:35], s6 offen offset:1024 sc1
  ds_read_b64_tr_b16 a[128:129], v63 offset:0
  v_mfma_f32_32x32x16_bf16 v[80:95], a[0:3], v[132:135], 0
  buffer_load_dwordx4 v[172:175], v26, s[32:35], s6 offen offset:1024 sc1
  ds_read_b64_tr_b16 a[130:131], v63 offset:1024
  v_mfma_f32_32x32x16_bf16 v[96:111], a[4:7], v[128:131], 0
  buffer_load_dwordx4 v[176:179], v25, s[32:35], s7 offen offset:0 sc1
  ds_read_b64_tr_b16 a[132:133], v37 offset:0
  v_mfma_f32_32x32x16_bf16 v[112:127], a[4:7], v[132:135], 0
  buffer_load_dwordx4 v[180:183], v26, s[32:35], s7 offen offset:0 sc1
  ds_read_b64_tr_b16 a[134:135], v37 offset:1024
  s_waitcnt vmcnt(10)
  v_mfma_f32_32x32x16_bf16 v[64:79], a[8:11], v[136:139], v[64:79]
  buffer_load_dwordx4 v[184:187], v25, s[32:35], s7 offen offset:1024 sc1
  ds_read_b64_tr_b16 a[136:137], v63 offset:2048
  v_mfma_f32_32x32x16_bf16 v[80:95], a[8:11], v[140:143], v[80:95]
  buffer_load_dwordx4 v[188:191], v26, s[32:35], s7 offen offset:1024 sc1
  ds_read_b64_tr_b16 a[138:139], v63 offset:3072
  v_mfma_f32_32x32x16_bf16 v[96:111], a[12:15], v[136:139], v[96:111]
  s_bfe_u32 s6, s4, 262160
  s_lshl_b32 s6, s6, 11
  s_add_u32 s6, s6, s11
  s_bfe_u32 s7, s4, 262164
  s_lshl_b32 s7, s7, 11
  s_add_u32 s7, s7, s11
  buffer_load_dwordx4 v[192:195], v25, s[32:35], s6 offen offset:0 sc1
  ds_read_b64_tr_b16 a[140:141], v37 offset:2048
  v_mfma_f32_32x32x16_bf16 v[112:127], a[12:15], v[140:143], v[112:127]
  buffer_load_dwordx4 v[196:199], v26, s[32:35], s6 offen offset:0 sc1
  ds_read_b64_tr_b16 a[142:143], v37 offset:3072
  s_waitcnt vmcnt(12)
  v_mfma_f32_32x32x16_bf16 v[64:79], a[16:19], v[144:147], v[64:79]
  buffer_load_dwordx4 v[200:203], v25, s[32:35], s6 offen offset:1024 sc1
  ds_read_b64_tr_b16 a[144:145], v63 offset:4096
  v_mfma_f32_32x32x16_bf16 v[80:95], a[16:19], v[148:151], v[80:95]
  buffer_load_dwordx4 v[204:207], v26, s[32:35], s6 offen offset:1024 sc1
  ds_read_b64_tr_b16 a[146:147], v63 offset:5120
  v_mfma_f32_32x32x16_bf16 v[96:111], a[20:23], v[144:147], v[96:111]
  buffer_load_dwordx4 v[208:211], v25, s[32:35], s7 offen offset:0 sc1
  ds_read_b64_tr_b16 a[148:149], v37 offset:4096
  v_mfma_f32_32x32x16_bf16 v[112:127], a[20:23], v[148:151], v[112:127]
  buffer_load_dwordx4 v[212:215], v26, s[32:35], s7 offen offset:0 sc1
  ds_read_b64_tr_b16 a[150:151], v37 offset:5120
  s_waitcnt vmcnt(14)
  v_mfma_f32_32x32x16_bf16 v[64:79], a[24:27], v[152:155], v[64:79]
  ds_read_b64_tr_b16 a[152:153], v63 offset:6144
  v_mfma_f32_32x32x16_bf16 v[80:95], a[24:27], v[156:159], v[80:95]
  buffer_load_dwordx4 v[216:219], v25, s[32:35], s7 offen offset:1024 sc1
  ds_read_b64_tr_b16 a[154:155], v63 offset:7168
  v_mfma_f32_32x32x16_bf16 v[96:111], a[28:31], v[152:155], v[96:111]
  ds_read_b64_tr_b16 a[156:157], v37 offset:6144
  v_mfma_f32_32x32x16_bf16 v[112:127], a[28:31], v[156:159], v[112:127]
  buffer_load_dwordx4 v[220:223], v26, s[32:35], s7 offen offset:1024 sc1
  ds_read_b64_tr_b16 a[158:159], v37 offset:7168
  s_waitcnt vmcnt(14)
  v_mfma_f32_32x32x16_bf16 v[64:79], a[32:35], v[160:163], v[64:79]
  ds_read_b64_tr_b16 a[160:161], v20 offset:0
  v_mfma_f32_32x32x16_bf16 v[80:95], a[32:35], v[164:167], v[80:95]
  s_mov_b32 s63, 0
L_pollB:
  v_cmp_ne_u32 vcc, v36, v31
  s_nop 0
  s_and_b32 s60, vcc_lo, 0xffff
  s_cbranch_scc0 L_pollB_go
  s_mov_b64 exec, 0xffff
  buffer_load_dword v36, v29, s[32:35], 0 offen sc1
  s_mov_b64 exec, -1
  s_waitcnt vmcnt(0)
  s_add_u32 s63, s63, 1
  s_cmp_lt_u32 s63, 0x40000
  s_cbranch_scc1 L_pollB
L_pollB_go:
  s_bfe_u32 s6, s4, 262168
  s_lshl_b32 s6, s6, 11
  s_add_u32 s6, s6, s11
  s_bfe_u32 s7, s4, 262172
  s_lshl_b32 s7, s7, 11
  s_add_u32 s7, s7, s11
  buffer_load_dwordx4 v[224:227], v25, s[32:35], s6 offen offset:0 sc1
  ds_read_b64_tr_b16 a[162:163], v20 offset:1024
  v_mfma_f32_32x32x16_bf16 v[96:111], a[36:39], v[160:163], v[96:111]
  ds_read_b64_tr_b16 a[164:165], v21 offset:0
  v_mfma_f32_32x32x16_bf16 v[112:127], a[36:39], v[164:167], v[112:127]
  buffer_load_dwordx4 v[228:231], v26, s[32:35], s6 offen offset:0 sc1
  ds_read_b64_tr_b16 a[166:167], v21 offset:1024
  s_waitcnt vmcnt(14)
  v_mfma_f32_32x32x16_bf16 v[64:79], a[40:43], v[168:171], v[64:79]
  ds_read_b64_tr_b16 a[168:169], v20 offset:2048
  v_mfma_f32_32x32x16_bf16 v[80:95], a[40:43], v[172:175], v[80:95]
  buffer_load_dwordx4 v[232:235], v25, s[32:35], s6 offen offset:1024 sc1
  ds_read_b64_tr_b16 a[170:171], v20 offset:3072
  v_mfma_f32_32x32x16_bf16 v[96:111], a[44:47], v[168:171], v[96:111]
  ds_read_b64_tr_b16 a[172:173], v21 offset:2048
  v_mfma_f32_32x32x16_bf16 v[112:127], a[44:47], v[172:175], v[112:127]
  buffer_load_dwordx4 v[236:239], v26, s[32:35], s6 offen offset:1024 sc1
  ds_read_b64_tr_b16 a[174:175], v21 offset:3072
  s_waitcnt vmcnt(14)
  v_mfma_f32_32x32x16_bf16 v[64:79], a[48:51], v[176:179], v[64:79]
  ds_read_b64_tr_b16 a[176:177], v20 offset:4096
  v_mfma_f32_32x32x16_bf16 v[80:95], a[48:51], v[180:183], v[80:95]
  buffer_load_dwordx4 v[240:243], v25, s[32:35], s7 offen offset:0 sc1
  ds_read_b64_tr_b16 a[178:179], v20 offset:5120
  v_mfma_f32_32x32x16_bf16 v[96:111], a[52:55], v[176:179], v[96:111]
  ds_read_b64_tr_b16 a[180:181], v21 offset:4096
  v_mfma_f32_32x32x16_bf16 v[112:127], a[52:55], v[180:183], v[112:127]
  buffer_load_dwordx4 v[244:247], v26, s[32:35], s7 offen offset:0 sc1
  ds_read_b64_tr_b16 a[182:183], v21 offset:5120
  s_waitcnt vmcnt(14)
  v_mfma_f32_32x32x16_bf16 v[64:79], a[56:59], v[184:187], v[64:79]
  ds_read_b64_tr_b16 a[184:185], v20 offset:6144
  v_mfma_f32_32x32x16_bf16 v[80:95], a[56:59], v[188:191], v[80:95]
  buffer_load_dwordx4 v[248:251], v25, s[32:35], s7 offen offset:1024 sc1
  ds_read_b64_tr_b16 a[186:187], v20 offset:7168
  v_mfma_f32_32x32x16_bf16 v[96:111], a[60:63], v[184:187], v[96:111]
  ds_read_b64_tr_b16 a[188:189], v21 offset:6144
  v_mfma_f32_32x32x16_bf16 v[112:127], a[60:63], v[188:191], v[112:127]
  buffer_load_dwordx4 v[252:255], v26, s[32:35], s7 offen offset:1024 sc1
  ds_read_b64_tr_b16 a[190:191], v21 offset:7168
  s_waitcnt lgkmcnt(15)
  s_waitcnt vmcnt(14)
  v_mfma_f32_32x32x16_bf16 v[64:79], a[64:67], v[192:195], v[64:79]
  ds_read_b64_tr_b16 a[192:193], v20 offset:32768
  v_mfma_f32_32x32x16_bf16 v[80:95], a[64:67], v[196:199], v[80:95]
  s_bfe_u32 s6, s5, 262144
  s_lshl_b32 s6, s6, 11
  s_add_u32 s6, s6, s11
  s_bfe_u32 s7, s5, 262148
  s_lshl_b32 s7, s7, 11
  s_add_u32 s7, s7, s11
  buffer_load_dwordx4 v[128:131], v25, s[32:35], s6 offen offset:0 sc1
  ds_read_b64_tr_b16 a[194:195], v20 offset:33792
  v_mfma_f32_32x32x16_bf16 v[96:111], a[68:71], v[192:195], v[96:111]
  ds_read_b64_tr_b16 a[196:197], v21 offset:32768
  v_mfma_f32_32x32x16_bf16 v[112:127], a[68:71], v[196:199], v[112:127]
  buffer_load_dwordx4 v[132:135], v26, s[32:35], s6 offen offset:0 sc1
  ds_read_b64_tr_b16 a[198:199], v21 offset:33792
  s_waitcnt vmcnt(14)
  v_mfma_f32_32x32x16_bf16 v[64:79], a[72:75], v[200:203], v[64:79]
  ds_read_b64_tr_b16 a[200:201], v20 offset:34816
  v_mfma_f32_32x32x16_bf16 v[80:95], a[72:75], v[204:207], v[80:95]
  buffer_load_dwordx4 v[136:139], v25, s[32:35], s6 offen offset:1024 sc1
  ds_read_b64_tr_b16 a[202:203], v20 offset:35840
  v_mfma_f32_32x32x16_bf16 v[96:111], a[76:79], v[200:203], v[96:111]
  ds_read_b64_tr_b16 a[204:205], v21 offset:34816
  v_mfma_f32_32x32x16_bf16 v[112:127], a[76:79], v[204:207], v[112:127]
  buffer_load_dwordx4 v[140:143], v26, s[32:35], s6 offen offset:1024 sc1
  ds_read_b64_tr_b16 a[206:207], v21 offset:35840
  s_waitcnt vmcnt(14)
  v_mfma_f32_32x32x16_bf16 v[64:79], a[80:83], v[208:211], v[64:79]
  ds_read_b64_tr_b16 a[208:209], v20 offset:36864
  v_mfma_f32_32x32x16_bf16 v[80:95], a[80:83], v[212:215], v[80:95]
  buffer_load_dwordx4 v[144:147], v25, s[32:35], s7 offen offset:0 sc1
  ds_read_b64_tr_b16 a[210:211], v20 offset:37888
  v_mfma_f32_32x32x16_bf16 v[96:111], a[84:87], v[208:211], v[96:111]
  ds_read_b64_tr_b16 a[212:213], v21 offset:36864
  v_mfma_f32_32x32x16_bf16 v[112:127], a[84:87], v[212:215], v[112:127]
  buffer_load_dwordx4 v[148:151], v26, s[32:35], s7 offen offset:0 sc1
  ds_read_b64_tr_b16 a[214:215], v21 offset:37888
  s_waitcnt vmcnt(14)
  v_mfma_f32_32x32x16_bf16 v[64:79], a[88:91], v[216:219], v[64:79]
  ds_read_b64_tr_b16 a[216:217], v20 offset:38912
  v_mfma_f32_32x32x16_bf16 v[80:95], a[88:91], v[220:223], v[80:95]
  buffer_load_dwordx4 v[152:155], v25, s[32:35], s7 offen offset:1024 sc1
  ds_read_b64_tr_b16 a[218:219], v20 offset:39936
  v_mfma_f32_32x32x16_bf16 v[96:111], a[92:95], v[216:219], v[96:111]
  ds_read_b64_tr_b16 a[220:221], v21 offset:38912
  v_mfma_f32_32x32x16_bf16 v[112:127], a[92:95], v[220:223], v[112:127]
  buffer_load_dwordx4 v[156:159], v26, s[32:35], s7 offen offset:1024 sc1
  ds_read_b64_tr_b16 a[222:223], v21 offset:39936
  s_waitcnt lgkmcnt(15)
  s_waitcnt vmcnt(14)
  v_mfma_f32_32x32x16_bf16 v[64:79], a[96:99], v[224:227], v[64:79]
  v_mfma_f32_32x32x16_bf16 v[80:95], a[96:99], v[228:231], v[80:95]
  s_bfe_u32 s6, s5, 262152
  s_lshl_b32 s6, s6, 11
  s_add_u32 s6, s6, s11
  s_bfe_u32 s7, s5, 262156
  s_lshl_b32 s7, s7, 11
  s_add_u32 s7, s7, s11
  buffer_load_dwordx4 v[160:163], v25, s[32:35], s6 offen offset:0 sc1
  v_mfma_f32_32x32x16_bf16 v[96:111], a[100:103], v[224:227], v[96:111]
  v_mfma_f32_32x32x16_bf16 v[112:127], a[100:103], v[228:231], v[112:127]
  buffer_load_dwordx4 v[164:167], v26, s[32:35], s6 offen offset:0 sc1
  s_waitcnt vmcnt(14)
  v_mfma_f32_32x32x16_bf16 v[64:79], a[104:107], v[232:235], v[64:79]
  v_mfma_f32_32x32x16_bf16 v[80:95], a[104:107], v[236:239], v[80:95]
  buffer_load_dwordx4 v[168:171], v25, s[32:35], s6 offen offset:1024 sc1
  v_mfma_f32_32x32x16_bf16 v[96:111], a[108:111], v[232:235], v[96:111]
  v_mfma_f32_32x32x16_bf16 v[112:127], a[108:111], v[236:239], v[112:127]
  buffer_load_dwordx4 v[172:175], v26, s[32:35], s6 offen offset:1024 sc1
  s_waitcnt vmcnt(14)
  v_mfma_f32_32x32x16_bf16 v[64:79], a[112:115], v[240:243], v[64:79]
  v_mfma_f32_32x32x16_bf16 v[80:95], a[112:115], v[244:247], v[80:95]
  buffer_load_dwordx4 v[176:179], v25, s[32:35], s7 offen offset:0 sc1
  v_mfma_f32_32x32x16_bf16 v[96:111], a[116:119], v[240:243], v[96:111]
  v_mfma_f32_32x32x16_bf16 v[112:127], a[116:119], v[244:247], v[112:127]
  buffer_load_dwordx4 v[180:183], v26, s[32:35], s7 offen offset:0 sc1
  s_waitcnt vmcnt(14)
  v_mfma_f32_32x32x16_bf16 v[64:79], a[120:123], v[248:251], v[64:79]
  v_mfma_f32_32x32x16_bf16 v[80:95], a[120:123], v[252:255], v[80:95]
  buffer_load_dwordx4 v[184:187], v25, s[32:35], s7 offen offset:1024 sc1
  v_mfma_f32_32x32x16_bf16 v[96:111], a[124:127], v[248:251], v[96:111]
  v_mfma_f32_32x32x16_bf16 v[112:127], a[124:127], v[252:255], v[112:127]
  buffer_load_dwordx4 v[188:191], v26, s[32:35], s7 offen offset:1024 sc1
  s_waitcnt lgkmcnt(15)
  s_waitcnt vmcnt(14)
  v_mfma_f32_32x32x16_bf16 v[64:79], a[128:131], v[128:131], v[64:79]
  v_mfma_f32_32x32x16_bf16 v[80:95], a[128:131], v[132:135], v[80:95]
  s_bfe_u32 s6, s5, 262160
  s_lshl_b32 s6, s6, 11
  s_add_u32 s6, s6, s11
  s_bfe_u32 s7, s5, 262164
  s_lshl_b32 s7, s7, 11
  s_add_u32 s7, s7, s11
  buffer_load_dwordx4 v[196:199], v26, s[32:35], s6 offen offset:0 sc1
  v_mfma_f32_32x32x16_bf16 v[96:111], a[132:135], v[128:131], v[96:111]
  v_mfma_f32_32x32x16_bf16 v[112:127], a[132:135], v[132:135], v[112:127]
  buffer_load_dwordx4 v[204:207], v26, s[32:35], s6 offen offset:1024 sc1
  s_waitcnt vmcnt(14)
  v_mfma_f32_32x32x16_bf16 v[64:79], a[136:139], v[136:139], v[64:79]
  v_mfma_f32_32x32x16_bf16 v[80:95], a[136:139], v[140:143], v[80:95]
  buffer_load_dwordx4 v[212:215], v26, s[32:35], s7 offen offset:0 sc1
  v_mfma_f32_32x32x16_bf16 v[96:111], a[140:143], v[136:139], v[96:111]
  v_mfma_f32_32x32x16_bf16 v[112:127], a[140:143], v[140:143], v[112:127]
  buffer_load_dwordx4 v[220:223], v26, s[32:35], s7 offen offset:1024 sc1
  s_waitcnt vmcnt(14)
  v_mfma_f32_32x32x16_bf16 v[64:79], a[144:147], v[144:147], v[64:79]
  v_mfma_f32_32x32x16_bf16 v[80:95], a[144:147], v[148:151], v[80:95]
  buffer_load_dwordx4 v[192:195], v25, s[32:35], s6 offen offset:0 sc1
  v_mfma_f32_32x32x16_bf16 v[96:111], a[148:151], v[144:147], v[96:111]
  v_mfma_f32_32x32x16_bf16 v[112:127], a[148:151], v[148:151], v[112:127]
  buffer_load_dwordx4 v[200:203], v25, s[32:35], s6 offen offset:1024 sc1
  s_waitcnt vmcnt(14)
  v_mfma_f32_32x32x16_bf16 v[64:79], a[152:155], v[152:155], v[64:79]
  v_mfma_f32_32x32x16_bf16 v[80:95], a[152:155], v[156:159], v[80:95]
  buffer_load_dwordx4 v[208:211], v25, s[32:35], s7 offen offset:0 sc1
  v_mfma_f32_32x32x16_bf16 v[96:111], a[156:159], v[152:155], v[96:111]
  v_mfma_f32_32x32x16_bf16 v[112:127], a[156:159], v[156:159], v[112:127]
  buffer_load_dwordx4 v[216:219], v25, s[32:35], s7 offen offset:1024 sc1
  s_waitcnt lgkmcnt(15)
  s_waitcnt vmcnt(14)
  v_mfma_f32_32x32x16_bf16 v[64:79], a[160:163], v[160:163], v[64:79]
  v_mfma_f32_32x32x16_bf16 v[80:95], a[160:163], v[164:167], v[80:95]
  v_mfma_f32_32x32x16_bf16 v[96:111], a[164:167], v[160:163], v[96:111]
  v_mfma_f32_32x32x16_bf16 v[112:127], a[164:167], v[164:167], v[112:127]
  s_waitcnt vmcnt(12)
  v_mfma_f32_32x32x16_bf16 v[64:79], a[168:171], v[168:171], v[64:79]
  v_mfma_f32_32x32x16_bf16 v[80:95], a[168:171], v[172:175], v[80:95]
  v_mfma_f32_32x32x16_bf16 v[96:111], a[172:175], v[168:171], v[96:111]
  v_mfma_f32_32x32x16_bf16 v[112:127], a[172:175], v[172:175], v[112:127]
  s_waitcnt vmcnt(10)
  v_mfma_f32_32x32x16_bf16 v[64:79], a[176:179], v[176:179], v[64:79]
  v_mfma_f32_32x32x16_bf16 v[80:95], a[176:179], v[180:183], v[80:95]
  v_mfma_f32_32x32x16_bf16 v[96:111], a[180:183], v[176:179], v[96:111]
  v_mfma_f32_32x32x16_bf16 v[112:127], a[180:183], v[180:183], v[112:127]
  s_waitcnt vmcnt(8)
  v_mfma_f32_32x32x16_bf16 v[64:79], a[184:187], v[184:187], v[64:79]
  v_mfma_f32_32x32x16_bf16 v[80:95], a[184:187], v[188:191], v[80:95]
  v_mfma_f32_32x32x16_bf16 v[96:111], a[188:191], v[184:187], v[96:111]
  v_mfma_f32_32x32x16_bf16 v[112:127], a[188:191], v[188:191], v[112:127]
  s_waitcnt lgkmcnt(0)
  s_waitcnt vmcnt(7)
  v_mfma_f32_32x32x16_bf16 v[80:95], a[192:195], v[196:199], v[80:95]
  v_mfma_f32_32x32x16_bf16 v[112:127], a[196:199], v[196:199], v[112:127]
  s_waitcnt vmcnt(6)
  v_mfma_f32_32x32x16_bf16 v[80:95], a[200:203], v[204:207], v[80:95]
  v_mfma_f32_32x32x16_bf16 v[112:127], a[204:207], v[204:207], v[112:127]
  s_waitcnt vmcnt(5)
  v_mfma_f32_32x32x16_bf16 v[80:95], a[208:211], v[212:215], v[80:95]
  v_mfma_f32_32x32x16_bf16 v[112:127], a[212:215], v[212:215], v[112:127]
  s_waitcnt vmcnt(4)
  v_mfma_f32_32x32x16_bf16 v[80:95], a[216:219], v[220:223], v[80:95]
  v_mfma_f32_32x32x16_bf16 v[112:127], a[220:223], v[220:223], v[112:127]
  v_lshlrev_b32 v224, 16, v46
  v_and_b32 v225, 0xffff0000, v46
  v_lshlrev_b32 v226, 16, v47
  v_and_b32 v227, 0xffff0000, v47
  v_lshlrev_b32 v228, 16, v48
  v_and_b32 v229, 0xffff0000, v48
  v_lshlrev_b32 v230, 16, v49
  v_and_b32 v231, 0xffff0000, v49
  v_lshlrev_b32 v232, 16, v50
  v_and_b32 v233, 0xffff0000, v50
  v_lshlrev_b32 v234, 16, v51
  v_and_b32 v235, 0xffff0000, v51
  s_waitcnt vmcnt(3)
  v_mfma_f32_32x32x16_bf16 v[96:111], a[196:199], v[192:195], v[96:111]
  ds_write_b128 v38, v[80:83] offset:0
  ds_write_b128 v38, v[84:87] offset:1024
  s_waitcnt vmcnt(2)
  v_mfma_f32_32x32x16_bf16 v[96:111], a[204:207], v[200:203], v[96:111]
  ds_write_b128 v38, v[88:91] offset:2048
  ds_write_b128 v38, v[92:95] offset:3072
  s_waitcnt vmcnt(1)
  v_mfma_f32_32x32x16_bf16 v[96:111], a[212:215], v[208:211], v[96:111]
  ds_write_b128 v38, v[112:115] offset:32768
  ds_write_b128 v38, v[116:119] offset:33792
  s_waitcnt vmcnt(0)
  v_mfma_f32_32x32x16_bf16 v[96:111], a[220:223], v[216:219], v[96:111]
  ds_write_b128 v38, v[120:123] offset:34816
  ds_write_b128 v38, v[124:127] offset:35840
  v_mfma_f32_32x32x16_bf16 v[64:79], a[192:195], v[192:195], v[64:79]
  v_lshlrev_b32 v236, 16, v52
  v_and_b32 v237, 0xffff0000, v52
  v_mfma_f32_32x32x16_bf16 v[64:79], a[200:203], v[200:203], v[64:79]
  v_lshlrev_b32 v238, 16, v53
  v_and_b32 v239, 0xffff0000, v53
  v_mfma_f32_32x32x16_bf16 v[64:79], a[208:211], v[208:211], v[64:79]
  v_and_b32 v42, 31, v1
  v_lshrrev_b32 v43, 5, v1
  v_mfma_f32_32x32x16_bf16 v[64:79], a[216:219], v[216:219], v[64:79]
  v_mul_u32_u24 v42, 896, v42
  v_lshl_add_u32 v42, v43, 4, v42
  ds_write_b128 v38, v[96:99] offset:4096
  ds_write_b128 v38, v[100:103] offset:5120
  ds_write_b128 v38, v[104:107] offset:6144
  ds_write_b128 v38, v[108:111] offset:7168
  s_lshl_b32 s60, s59, 1
  s_and_b32 s61, s52, 1
  s_add_u32 s60, s60, s61
  s_mul_i32 s60, s60, 28672
  s_lshl_b32 s61, s55, 7
  s_add_u32 s60, s60, s61
  s_lshr_b32 s61, s52, 1
  s_lshl_b32 s61, s61, 6
  s_add_u32 s60, s60, s61
  s_waitcnt lgkmcnt(0)
  s_barrier
  ds_read_b128 v[128:131], v39 offset:0
  ds_read_b128 v[132:135], v39 offset:1024
  ds_read_b128 v[136:139], v39 offset:2048
  ds_read_b128 v[140:143], v39 offset:3072
  ds_read_b128 v[144:147], v40 offset:0
  ds_read_b128 v[148:151], v40 offset:1024
  ds_read_b128 v[152:155], v40 offset:2048
  ds_read_b128 v[156:159], v40 offset:3072
  ds_read_b128 v[160:163], v41 offset:0
  ds_read_b128 v[164:167], v41 offset:1024
  ds_read_b128 v[168:171], v41 offset:2048
  ds_read_b128 v[172:175], v41 offset:3072
  v_pk_add_f32 v[64:65], v[64:65], v[224:225]
  v_pk_add_f32 v[66:67], v[66:67], v[226:227]
  v_pk_add_f32 v[68:69], v[68:69], v[228:229]
  v_pk_add_f32 v[70:71], v[70:71], v[230:231]
  v_pk_add_f32 v[72:73], v[72:73], v[232:233]
  v_pk_add_f32 v[74:75], v[74:75], v[234:235]
  v_pk_add_f32 v[76:77], v[76:77], v[236:237]
  v_pk_add_f32 v[78:79], v[78:79], v[238:239]
  s_waitcnt lgkmcnt(8)
  v_pk_add_f32 v[64:65], v[64:65], v[128:129]
  v_pk_add_f32 v[66:67], v[66:67], v[130:131]
  v_pk_add_f32 v[68:69], v[68:69], v[132:133]
  v_pk_add_f32 v[70:71], v[70:71], v[134:135]
  v_pk_add_f32 v[72:73], v[72:73], v[136:137]
  v_pk_add_f32 v[74:75], v[74:75], v[138:139]
  v_pk_add_f32 v[76:77], v[76:77], v[140:141]
  v_pk_add_f32 v[78:79], v[78:79], v[142:143]
  s_waitcnt lgkmcnt(4)
  v_pk_add_f32 v[64:65], v[64:65], v[144:145]
  v_pk_add_f32 v[66:67], v[66:67], v[146:147]
  v_pk_add_f32 v[68:69], v[68:69], v[148:149]
  v_pk_add_f32 v[70:71], v[70:71], v[150:151]
  v_pk_add_f32 v[72:73], v[72:73], v[152:153]
  v_pk_add_f32 v[74:75], v[74:75], v[154:155]
  v_pk_add_f32 v[76:77], v[76:77], v[156:157]
  v_pk_add_f32 v[78:79], v[78:79], v[158:159]
  s_waitcnt lgkmcnt(0)
  v_pk_add_f32 v[64:65], v[64:65], v[160:161]
  v_pk_add_f32 v[66:67], v[66:67], v[162:163]
  v_pk_add_f32 v[68:69], v[68:69], v[164:165]
  v_pk_add_f32 v[70:71], v[70:71], v[166:167]
  v_pk_add_f32 v[72:73], v[72:73], v[168:169]
  v_pk_add_f32 v[74:75], v[74:75], v[170:171]
  v_pk_add_f32 v[76:77], v[76:77], v[172:173]
  v_pk_add_f32 v[78:79], v[78:79], v[174:175]
  v_cvt_pk_bf16_f32 v208, v64, v65
  v_cvt_pk_bf16_f32 v209, v66, v67
  v_cvt_pk_bf16_f32 v210, v68, v69
  v_cvt_pk_bf16_f32 v211, v70, v71
  v_cvt_pk_bf16_f32 v212, v72, v73
  v_cvt_pk_bf16_f32 v213, v74, v75
  v_cvt_pk_bf16_f32 v214, v76, v77
  v_cvt_pk_bf16_f32 v215, v78, v79
  s_nop 1
  v_permlane32_swap_b32 v208, v210
  v_permlane32_swap_b32 v209, v211
  v_permlane32_swap_b32 v212, v214
  v_permlane32_swap_b32 v213, v215
  buffer_store_dwordx4 v[208:211], v42, s[36:39], s60 offen offset:0
  buffer_store_dwordx4 v[212:215], v42, s[36:39], s60 offen offset:32
L_end:
  s_endpgm
L_spare:
  s_cmp_ge_u32 s2, 256
  s_cbranch_scc1 L_end2
  s_load_dwordx2 s[4:5], s[0:1], 24
  s_load_dwordx2 s[6:7], s[0:1], 8
  s_load_dwordx2 s[32:33], s[0:1], 56
  v_and_b32 v1, 63, v0
  v_lshrrev_b32 v2, 6, v0
  s_and_b32 s8, s2, 7
  v_readfirstlane_b32 s9, v2
  s_sub_u32 s14, s2, 224
  s_lshr_b32 s10, s14, 3
  s_mul_i32 s10, s10, 401408
  s_mul_i32 s11, s8, 50176
  s_lshl_b32 s12, s9, 13
  s_add_u32 s11, s11, s12
  v_lshlrev_b32 v3, 7, v1
  s_mov_b32 s22, 1605632
  s_mov_b32 s23, 0x20000
  s_mov_b32 s26, 1605632
  s_mov_b32 s27, 0x20000
  s_mov_b32 s34, 0x10000000
  s_mov_b32 s35, 0x20000
  s_lshl_b32 s13, s14, 2
  s_add_u32 s13, s13, s9
  s_mul_i32 s13, s13, 12544
  v_min_u32 v6, 48, v1
  v_lshlrev_b32 v6, 8, v6
  s_waitcnt lgkmcnt(0)
  s_mov_b32 s20, s4
  s_mov_b32 s21, s5
  s_mov_b32 s24, s6
  s_mov_b32 s25, s7
  buffer_load_dword v7, v6, s[24:27], s13 offen offset:128
  v_add_u32 v4, s11, v3
  v_subrev_u32 v5, 401408, v4
  v_min_u32 v4, v4, v5
  buffer_load_dword v24, v4, s[20:23], s10 offen
  s_add_u32 s11, s11, 32768
  s_sub_u32 s12, s11, 401408
  s_min_u32 s11, s11, s12
  v_add_u32 v4, s11, v3
  v_subrev_u32 v5, 401408, v4
  v_min_u32 v4, v4, v5
  buffer_load_dword v25, v4, s[20:23], s10 offen
  s_add_u32 s11, s11, 32768
  s_sub_u32 s12, s11, 401408
  s_min_u32 s11, s11, s12
  s_lshr_b32 s40, s14, 3
  s_and_b32 s40, s40, 1
  s_mul_i32 s41, s40, 7
  s_sub_u32 s42, 28, s41
  s_add_u32 s43, s41, 21
  s_mul_i32 s44, s8, s42
  s_lshr_b32 s44, s44, 3
  s_mul_i32 s45, s8, s43
  s_lshr_b32 s45, s45, 3
  s_xor_b32 s46, s40, 1
  s_add_u32 s47, s9, 0
  s_min_u32 s47, s47, 48
  s_sub_u32 s48, s47, s42
  s_cmp_lt_u32 s47, s42
  s_cselect_b32 s47, s47, s48
  s_cselect_b32 s49, s44, s45
  s_cselect_b32 s50, s42, s43
  s_cselect_b32 s51, s40, s46
  s_add_u32 s47, s47, s49
  s_sub_u32 s48, s47, s50
  s_cmp_ge_u32 s47, s50
  s_cselect_b32 s47, s48, s47
  s_mul_i32 s48, s47, 37
  s_lshr_b32 s48, s48, 8
  s_add_u32 s49, s48, s51
  s_mul_i32 s49, s49, 7
  s_add_u32 s47, s47, s49
  s_lshl_b32 s47, s47, 13
  s_add_u32 s47, s47, s10
  buffer_load_dword v8, v3, s[20:23], s47 offen
  s_add_u32 s47, s9, 4
  s_min_u32 s47, s47, 48
  s_sub_u32 s48, s47, s42
  s_cmp_lt_u32 s47, s42
  s_cselect_b32 s47, s47, s48
  s_cselect_b32 s49, s44, s45
  s_cselect_b32 s50, s42, s43
  s_cselect_b32 s51, s40, s46
  s_add_u32 s47, s47, s49
  s_sub_u32 s48, s47, s50
  s_cmp_ge_u32 s47, s50
  s_cselect_b32 s47, s48, s47
  s_mul_i32 s48, s47, 37
  s_lshr_b32 s48, s48, 8
  s_add_u32 s49, s48, s51
  s_mul_i32 s49, s49, 7
  s_add_u32 s47, s47, s49
  s_lshl_b32 s47, s47, 13
  s_add_u32 s47, s47, s10
  buffer_load_dword v9, v3, s[20:23], s47 offen
  s_add_u32 s47, s9, 8
  s_min_u32 s47, s47, 48
  s_sub_u32 s48, s47, s42
  s_cmp_lt_u32 s47, s42
  s_cselect_b32 s47, s47, s48
  s_cselect_b32 s49, s44, s45
  s_cselect_b32 s50, s42, s43
  s_cselect_b32 s51, s40, s46
  s_add_u32 s47, s47, s49
  s_sub_u32 s48, s47, s50
  s_cmp_ge_u32 s47, s50
  s_cselect_b32 s47, s48, s47
  s_mul_i32 s48, s47, 37
  s_lshr_b32 s48, s48, 8
  s_add_u32 s49, s48, s51
  s_mul_i32 s49, s49, 7
  s_add_u32 s47, s47, s49
  s_lshl_b32 s47, s47, 13
  s_add_u32 s47, s47, s10
  buffer_load_dword v10, v3, s[20:23], s47 offen
  s_add_u32 s47, s9, 12
  s_min_u32 s47, s47, 48
  s_sub_u32 s48, s47, s42
  s_cmp_lt_u32 s47, s42
  s_cselect_b32 s47, s47, s48
  s_cselect_b32 s49, s44, s45
  s_cselect_b32 s50, s42, s43
  s_cselect_b32 s51, s40, s46
  s_add_u32 s47, s47, s49
  s_sub_u32 s48, s47, s50
  s_cmp_ge_u32 s47, s50
  s_cselect_b32 s47, s48, s47
  s_mul_i32 s48, s47, 37
  s_lshr_b32 s48, s48, 8
  s_add_u32 s49, s48, s51
  s_mul_i32 s49, s49, 7
  s_add_u32 s47, s47, s49
  s_lshl_b32 s47, s47, 13
  s_add_u32 s47, s47, s10
  buffer_load_dword v11, v3, s[20:23], s47 offen
  s_add_u32 s47, s9, 16
  s_min_u32 s47, s47, 48
  s_sub_u32 s48, s47, s42
  s_cmp_lt_u32 s47, s42
  s_cselect_b32 s47, s47, s48
  s_cselect_b32 s49, s44, s45
  s_cselect_b32 s50, s42, s43
  s_cselect_b32 s51, s40, s46
  s_add_u32 s47, s47, s49
  s_sub_u32 s48, s47, s50
  s_cmp_ge_u32 s47, s50
  s_cselect_b32 s47, s48, s47
  s_mul_i32 s48, s47, 37
  s_lshr_b32 s48, s48, 8
  s_add_u32 s49, s48, s51
  s_mul_i32 s49, s49, 7
  s_add_u32 s47, s47, s49
  s_lshl_b32 s47, s47, 13
  s_add_u32 s47, s47, s10
  buffer_load_dword v12, v3, s[20:23], s47 offen
  s_add_u32 s47, s9, 20
  s_min_u32 s47, s47, 48
  s_sub_u32 s48, s47, s42
  s_cmp_lt_u32 s47, s42
  s_cselect_b32 s47, s47, s48
  s_cselect_b32 s49, s44, s45
  s_cselect_b32 s50, s42, s43
  s_cselect_b32 s51, s40, s46
  s_add_u32 s47, s47, s49
  s_sub_u32 s48, s47, s50
  s_cmp_ge_u32 s47, s50
  s_cselect_b32 s47, s48, s47
  s_mul_i32 s48, s47, 37
  s_lshr_b32 s48, s48, 8
  s_add_u32 s49, s48, s51
  s_mul_i32 s49, s49, 7
  s_add_u32 s47, s47, s49
  s_lshl_b32 s47, s47, 13
  s_add_u32 s47, s47, s10
  buffer_load_dword v13, v3, s[20:23], s47 offen
  s_add_u32 s47, s9, 24
  s_min_u32 s47, s47, 48
  s_sub_u32 s48, s47, s42
  s_cmp_lt_u32 s47, s42
  s_cselect_b32 s47, s47, s48
  s_cselect_b32 s49, s44, s45
  s_cselect_b32 s50, s42, s43
  s_cselect_b32 s51, s40, s46
  s_add_u32 s47, s47, s49
  s_sub_u32 s48, s47, s50
  s_cmp_ge_u32 s47, s50
  s_cselect_b32 s47, s48, s47
  s_mul_i32 s48, s47, 37
  s_lshr_b32 s48, s48, 8
  s_add_u32 s49, s48, s51
  s_mul_i32 s49, s49, 7
  s_add_u32 s47, s47, s49
  s_lshl_b32 s47, s47, 13
  s_add_u32 s47, s47, s10
  buffer_load_dword v14, v3, s[20:23], s47 offen
  s_add_u32 s47, s9, 28
  s_min_u32 s47, s47, 48
  s_sub_u32 s48, s47, s42
  s_cmp_lt_u32 s47, s42
  s_cselect_b32 s47, s47, s48
  s_cselect_b32 s49, s44, s45
  s_cselect_b32 s50, s42, s43
  s_cselect_b32 s51, s40, s46
  s_add_u32 s47, s47, s49
  s_sub_u32 s48, s47, s50
  s_cmp_ge_u32 s47, s50
  s_cselect_b32 s47, s48, s47
  s_mul_i32 s48, s47, 37
  s_lshr_b32 s48, s48, 8
  s_add_u32 s49, s48, s51
  s_mul_i32 s49, s49, 7
  s_add_u32 s47, s47, s49
  s_lshl_b32 s47, s47, 13
  s_add_u32 s47, s47, s10
  buffer_load_dword v15, v3, s[20:23], s47 offen
  s_add_u32 s47, s9, 32
  s_min_u32 s47, s47, 48
  s_sub_u32 s48, s47, s42
  s_cmp_lt_u32 s47, s42
  s_cselect_b32 s47, s47, s48
  s_cselect_b32 s49, s44, s45
  s_cselect_b32 s50, s42, s43
  s_cselect_b32 s51, s40, s46
  s_add_u32 s47, s47, s49
  s_sub_u32 s48, s47, s50
  s_cmp_ge_u32 s47, s50
  s_cselect_b32 s47, s48, s47
  s_mul_i32 s48, s47, 37
  s_lshr_b32 s48, s48, 8
  s_add_u32 s49, s48, s51
  s_mul_i32 s49, s49, 7
  s_add_u32 s47, s47, s49
  s_lshl_b32 s47, s47, 13
  s_add_u32 s47, s47, s10
  buffer_load_dword v16, v3, s[20:23], s47 offen
  s_add_u32 s47, s9, 36
  s_min_u32 s47, s47, 48
  s_sub_u32 s48, s47, s42
  s_cmp_lt_u32 s47, s42
  s_cselect_b32 s47, s47, s48
  s_cselect_b32 s49, s44, s45
  s_cselect_b32 s50, s42, s43
  s_cselect_b32 s51, s40, s46
  s_add_u32 s47, s47, s49
  s_sub_u32 s48, s47, s50
  s_cmp_ge_u32 s47, s50
  s_cselect_b32 s47, s48, s47
  s_mul_i32 s48, s47, 37
  s_lshr_b32 s48, s48, 8
  s_add_u32 s49, s48, s51
  s_mul_i32 s49, s49, 7
  s_add_u32 s47, s47, s49
  s_lshl_b32 s47, s47, 13
  s_add_u32 s47, s47, s10
  buffer_load_dword v17, v3, s[20:23], s47 offen
  s_add_u32 s47, s9, 40
  s_min_u32 s47, s47, 48
  s_sub_u32 s48, s47, s42
  s_cmp_lt_u32 s47, s42
  s_cselect_b32 s47, s47, s48
  s_cselect_b32 s49, s44, s45
  s_cselect_b32 s50, s42, s43
  s_cselect_b32 s51, s40, s46
  s_add_u32 s47, s47, s49
  s_sub_u32 s48, s47, s50
  s_cmp_ge_u32 s47, s50
  s_cselect_b32 s47, s48, s47
  s_mul_i32 s48, s47, 37
  s_lshr_b32 s48, s48, 8
  s_add_u32 s49, s48, s51
  s_mul_i32 s49, s49, 7
  s_add_u32 s47, s47, s49
  s_lshl_b32 s47, s47, 13
  s_add_u32 s47, s47, s10
  buffer_load_dword v18, v3, s[20:23], s47 offen
  s_add_u32 s47, s9, 44
  s_min_u32 s47, s47, 48
  s_sub_u32 s48, s47, s42
  s_cmp_lt_u32 s47, s42
  s_cselect_b32 s47, s47, s48
  s_cselect_b32 s49, s44, s45
  s_cselect_b32 s50, s42, s43
  s_cselect_b32 s51, s40, s46
  s_add_u32 s47, s47, s49
  s_sub_u32 s48, s47, s50
  s_cmp_ge_u32 s47, s50
  s_cselect_b32 s47, s48, s47
  s_mul_i32 s48, s47, 37
  s_lshr_b32 s48, s48, 8
  s_add_u32 s49, s48, s51
  s_mul_i32 s49, s49, 7
  s_add_u32 s47, s47, s49
  s_lshl_b32 s47, s47, 13
  s_add_u32 s47, s47, s10
  buffer_load_dword v19, v3, s[20:23], s47 offen
  s_add_u32 s47, s9, 48
  s_min_u32 s47, s47, 48
  s_sub_u32 s48, s47, s42
  s_cmp_lt_u32 s47, s42
  s_cselect_b32 s47, s47, s48
  s_cselect_b32 s49, s44, s45
  s_cselect_b32 s50, s42, s43
  s_cselect_b32 s51, s40, s46
  s_add_u32 s47, s47, s49
  s_sub_u32 s48, s47, s50
  s_cmp_ge_u32 s47, s50
  s_cselect_b32 s47, s48, s47
  s_mul_i32 s48, s47, 37
  s_lshr_b32 s48, s48, 8
  s_add_u32 s49, s48, s51
  s_mul_i32 s49, s49, 7
  s_add_u32 s47, s47, s49
  s_lshl_b32 s47, s47, 13
  s_add_u32 s47, s47, s10
  buffer_load_dword v20, v3, s[20:23], s47 offen
  s_waitcnt vmcnt(0)
L_end2:
  s_endpgm
.section .rodata,"a"
.p2align 6
.amdhsa_kernel standalone__dense_activation_gelu__prompt_kernel
  .amdhsa_next_free_vgpr 512
  .amdhsa_next_free_sgpr 102
  .amdhsa_accum_offset 256
  .amdhsa_group_segment_fixed_size 0
  .amdhsa_kernarg_size 64
  .amdhsa_user_sgpr_count 2
  .amdhsa_user_sgpr_kernarg_segment_ptr 1
  .amdhsa_system_sgpr_workgroup_id_x 1
.end_amdhsa_kernel
```
